```python
import torch

def _softmax(x, axis=-1):
    return torch.softmax(x, dim=axis)

def _gelu(x):
    return torch.nn.functional.gelu(x, approximate='tanh')

def _silu(x):
    return torch.nn.functional.silu(x)

def _sigmoid(x):
    return torch.sigmoid(x)

def _layernorm(x, axis=-1, eps=1e-05):
    m = x.mean(dim=axis, keepdim=True)
    v = x.var(dim=axis, keepdim=True, unbiased=False)
    return (x - m) / torch.sqrt(v + eps)

def _scatter_add(tgt, idx, src, axis=0):
    return tgt.clone().index_add_(axis, idx, src)

def _segment_sum(src, seg, n):
    out = torch.zeros((n,) + src.shape[1:], dtype=src.dtype)
    return out.index_add_(0, seg, src)

def _pad(x, pw):
    flat = tuple((v for pair in reversed(pw) for v in pair))
    return torch.nn.functional.pad(x, flat)
kernel_name = 'adaLN_cond__mha_block_cached__glu_gated_geglu__decode'

def setup_inputs():

    _w = lambda a: (lambda t: t.to(torch.bfloat16) if t.is_floating_point() else t)(torch.as_tensor(a))

    def _A_setup():
        B, Sq, D = (1, 1, 512)
        H, Sk, Dh = (32, 65536, 128)
        return {'x': _w((lambda *s: torch.randn(*s, dtype=torch.bfloat16) * 0.05)(B, Sq, D)), 'k_cache': _w((lambda *s: torch.randn(*s, dtype=torch.bfloat16) * 0.8)(B, H, Sk, Dh)), 'v_cache': _w((lambda *s: torch.randn(*s, dtype=torch.bfloat16) * 3.2)(B, H, Sk, Dh)), 'wq': _w((lambda *s: torch.randn(*s, dtype=torch.bfloat16) * 0.8)(D, H * Dh) * D ** (-0.5)), 'wo': _w((lambda *s: torch.randn(*s, dtype=torch.bfloat16) * 3.2)(H * Dh, D) * (H * Dh) ** (-0.5))}
    _A_in = _A_setup()

    def _B_setup():
        B, S, Dm, Df = (1, 1, 512, 1792)
        return {'x': _w((lambda *s: torch.randn(*s, dtype=torch.bfloat16) * 0.05)(B, S, Dm)), 'w_gate': _w((lambda *s: torch.randn(*s, dtype=torch.bfloat16) * 3.2)(Dm, Df) * Dm ** (-0.5)), 'w_up': _w((lambda *s: torch.randn(*s, dtype=torch.bfloat16) * 3.2)(Dm, Df) * Dm ** (-0.5)), 'w_down': _w((lambda *s: torch.randn(*s, dtype=torch.bfloat16) * 3.2)(Df, Dm) * Df ** (-0.5))}
    _B_in = _B_setup()
    return {'A_x': _A_in['x'], 'A_k_cache': _A_in['k_cache'], 'A_v_cache': _A_in['v_cache'], 'A_wq': _A_in['wq'], 'A_wo': _A_in['wo'], 'B_x': _B_in['x'], 'B_w_gate': _B_in['w_gate'], 'B_w_up': _B_in['w_up'], 'B_w_down': _B_in['w_down'], 'c': _w((lambda *s: torch.randn(*s, dtype=torch.bfloat16) * 0.4)(1, 512) * 8.0), 'w_mod': _w((lambda *s: torch.randn(*s, dtype=torch.bfloat16) * 0.4)(512, 6 * 512) * 512 ** (-0.5) * 8.0)}

def reference(A_x, A_k_cache, A_v_cache, A_wq, A_wo, B_x, B_w_gate, B_w_up, B_w_down, c, w_mod):

    def _A_ref(x, k_cache, v_cache, wq, wo):
        B, Sq, D = x.shape
        H, Dh = (32, 128)
        q = (lambda x, *d: x.permute(*d))((x @ wq).reshape(B, Sq, H, Dh), 0, 2, 1, 3)
        scores = torch.einsum('bhqd,bhkd->bhqk', q, k_cache) * Dh ** (-0.5)
        p = _softmax(scores, axis=-1)
        o = torch.einsum('bhqk,bhkd->bhqd', p, v_cache)
        return (lambda x, *d: x.permute(*d))(o, 0, 2, 1, 3).reshape(B, Sq, H * Dh) @ wo

    def _B_ref(x, w_gate, w_up, w_down):
        g = torch.einsum('bsd,df->bsf', x, w_gate)
        u = torch.einsum('bsd,df->bsf', x, w_up)
        h = _gelu(g) * u
        return torch.einsum('bsf,fd->bsd', h, w_down)
    x = A_x
    mod = (_silu(c) @ w_mod).reshape(c.shape[0], 6, 1, -1)
    sa, ca, ga, sb, cb, gb = (mod[:, 0].clone(), mod[:, 1].clone(), mod[:, 2].clone(), mod[:, 3].clone(), mod[:, 4].clone(), mod[:, 5].clone())
    h = _layernorm(x, axis=-1) * (1 + ca) + sa
    x = x + ga * _A_ref(h, A_k_cache, A_v_cache, A_wq, A_wo)
    h = _layernorm(x, axis=-1) * (1 + cb) + sb
    x = x + gb * _B_ref(h, B_w_gate, B_w_up, B_w_down)
    return x
```

```asm
; @launch grid=(256,1,1) block=(512,1,1) lds=146432
.amdgcn_target "amdgcn-amd-amdhsa--gfx950"
.text
.globl adaLN_cond__mha_block_cached__glu_gated_geglu__decode_kernel
.p2align 8
.type adaLN_cond__mha_block_cached__glu_gated_geglu__decode_kernel,@function
adaLN_cond__mha_block_cached__glu_gated_geglu__decode_kernel:
  s_cmp_ge_u32 s2, 256
  s_cbranch_scc1 L_end
  s_load_dwordx16 s[16:31], s[0:1], 0
  s_load_dwordx8 s[32:39], s[0:1], 64
  s_load_dwordx4 s[40:43], s[0:1], 96
  v_lshrrev_b32 v1, 6, v0
  v_and_b32 v0, 63, v0
  v_readfirstlane_b32 s3, v1
  s_lshr_b32 s4, s2, 3
  s_and_b32 s5, s2, 7
  s_lshr_b32 s50, s4, 1
  s_mul_i32 s51, s50, 3
  s_sub_u32 s52, s5, s51
  s_and_b32 s52, s52, 7
  s_and_b32 s53, s4, 1
  s_add_u32 s58, s51, s52
  s_lshl_b32 s58, s58, 1
  s_add_u32 s58, s58, s53
  s_cmp_lt_u32 s52, 3
  s_cselect_b32 s58, s58, 255
  s_and_b32 s6, s3, 3
  s_cmp_ge_u32 s3, 4
  s_cbranch_scc1 L_helper
  s_lshl_b32 s44, s2, 21
  s_lshl_b32 s53, s6, 10
  s_add_u32 s44, s44, s53
  s_mov_b32 s45, s44
  v_lshlrev_b32 v1, 4, v0
  s_waitcnt lgkmcnt(0)
  s_mov_b32 s8, s18
  s_mov_b32 s9, s19
  s_mov_b32 s10, 0x20000000
  s_mov_b32 s11, 0x20000
  s_mov_b32 s12, s20
  s_mov_b32 s13, s21
  s_mov_b32 s14, 0x20000000
  s_mov_b32 s15, 0x20000
  buffer_load_dwordx4 v[96:99], v1, s[8:11], s44 offen nt
  s_add_u32 s44, s44, 4096
  buffer_load_dwordx4 v[100:103], v1, s[8:11], s44 offen nt
  s_add_u32 s44, s44, 4096
  buffer_load_dwordx4 v[104:107], v1, s[8:11], s44 offen nt
  s_add_u32 s44, s44, 4096
  buffer_load_dwordx4 v[108:111], v1, s[8:11], s44 offen nt
  s_add_u32 s44, s44, 4096
  buffer_load_dwordx4 v[112:115], v1, s[8:11], s44 offen nt
  s_add_u32 s44, s44, 4096
  buffer_load_dwordx4 v[116:119], v1, s[8:11], s44 offen nt
  s_add_u32 s44, s44, 4096
  s_barrier
  v_lshrrev_b32 v3, 4, v0
  v_lshlrev_b32 v3, 5, v3
  s_lshl_b32 s46, s6, 14
  s_add_u32 s46, s46, 13312
  v_add_u32 v3, s46, v3
  v_bfe_u32 v2, v0, 1, 3
  v_lshl_add_u32 v2, v2, 2, v3
  s_mov_b32 s48, 0xcccccccc
  s_mov_b32 s49, 0xcccccccc
  s_mov_b32 s47, 0x3db504f3
  s_mov_b32 s52, 0x3fb8aa3b
  v_mov_b32 v54, 0xff7fffff
  v_mov_b32 v55, 0
  v_mov_b32 v58, s6
  v_lshlrev_b32 v58, 2, v58
  v_and_b32 v50, 15, v0
  v_lshlrev_b32 v50, 5, v50
  v_mov_b32 v56, 12060
  v_mov_b32 v59, 7
  s_mov_b32 s70, 8388608
  s_waitcnt vmcnt(5)
  buffer_load_dwordx4 v[120:123], v1, s[8:11], s44 offen nt
  s_add_u32 s44, s44, 4096
  s_waitcnt vmcnt(5)
  buffer_load_dwordx4 v[124:127], v1, s[8:11], s44 offen nt
  s_add_u32 s44, s44, 4096
  s_waitcnt vmcnt(5)
  buffer_load_dwordx4 v[128:131], v1, s[8:11], s44 offen nt
  s_add_u32 s44, s44, 4096
  s_waitcnt vmcnt(5)
  buffer_load_dwordx4 v[132:135], v1, s[8:11], s44 offen nt
  s_add_u32 s44, s44, 4096
  s_waitcnt vmcnt(5)
  buffer_load_dwordx4 v[136:139], v1, s[8:11], s44 offen nt
  s_add_u32 s44, s44, 4096
  s_waitcnt vmcnt(5)
  buffer_load_dwordx4 v[140:143], v1, s[8:11], s44 offen nt
  s_add_u32 s44, s44, 4096
  s_waitcnt vmcnt(5)
  buffer_load_dwordx4 v[144:147], v1, s[8:11], s44 offen nt
  s_add_u32 s44, s44, 4096
  s_waitcnt vmcnt(5)
  buffer_load_dwordx4 v[148:151], v1, s[8:11], s44 offen nt
  s_add_u32 s44, s44, 4096
  s_waitcnt vmcnt(5)
  buffer_load_dwordx4 v[152:155], v1, s[8:11], s44 offen nt
  s_add_u32 s44, s44, 4096
  s_waitcnt vmcnt(5)
  buffer_load_dwordx4 v[156:159], v1, s[8:11], s44 offen nt
  s_add_u32 s44, s44, 4096
  s_waitcnt vmcnt(5)
  buffer_load_dwordx4 v[160:163], v1, s[8:11], s44 offen nt
  s_add_u32 s44, s44, 4096
  s_waitcnt vmcnt(5)
  buffer_load_dwordx4 v[164:167], v1, s[8:11], s44 offen nt
  s_add_u32 s44, s44, 4096
  s_waitcnt vmcnt(5)
  buffer_load_dwordx4 v[168:171], v1, s[8:11], s44 offen nt
  s_add_u32 s44, s44, 4096
  s_waitcnt vmcnt(5)
  buffer_load_dwordx4 v[172:175], v1, s[8:11], s44 offen nt
  s_add_u32 s44, s44, 4096
  s_waitcnt vmcnt(5)
  buffer_load_dwordx4 v[176:179], v1, s[8:11], s44 offen nt
  s_add_u32 s44, s44, 4096
  s_waitcnt vmcnt(5)
  buffer_load_dwordx4 v[180:183], v1, s[8:11], s44 offen nt
  s_add_u32 s44, s44, 4096
  s_waitcnt vmcnt(5)
  buffer_load_dwordx4 v[184:187], v1, s[8:11], s44 offen nt
  s_add_u32 s44, s44, 4096
  s_waitcnt vmcnt(5)
  buffer_load_dwordx4 v[188:191], v1, s[8:11], s44 offen nt
  s_add_u32 s44, s44, 4096
  s_waitcnt vmcnt(5)
  buffer_load_dwordx4 v[192:195], v1, s[8:11], s44 offen nt
  s_add_u32 s44, s44, 4096
  s_waitcnt vmcnt(5)
  buffer_load_dwordx4 v[196:199], v1, s[8:11], s44 offen nt
  s_add_u32 s44, s44, 4096
  s_waitcnt vmcnt(5)
  buffer_load_dwordx4 v[200:203], v1, s[8:11], s44 offen nt
  s_add_u32 s44, s44, 4096
  s_waitcnt vmcnt(5)
  buffer_load_dwordx4 v[204:207], v1, s[8:11], s44 offen nt
  s_add_u32 s44, s44, 4096
  s_waitcnt vmcnt(5)
  buffer_load_dwordx4 v[208:211], v1, s[8:11], s44 offen nt
  s_add_u32 s44, s44, 4096
  s_waitcnt vmcnt(5)
  buffer_load_dwordx4 v[212:215], v1, s[8:11], s44 offen nt
  s_add_u32 s44, s44, 4096
  s_waitcnt vmcnt(5)
  buffer_load_dwordx4 v[216:219], v1, s[8:11], s44 offen nt
  s_add_u32 s44, s44, 4096
  s_waitcnt vmcnt(5)
  buffer_load_dwordx4 v[220:223], v1, s[8:11], s44 offen nt
  s_add_u32 s44, s44, 4096
  s_waitcnt vmcnt(5)
  buffer_load_dwordx4 v[224:227], v1, s[8:11], s44 offen nt
  s_add_u32 s44, s44, 4096
  s_waitcnt vmcnt(5)
  buffer_load_dwordx4 v[228:231], v1, s[8:11], s44 offen nt
  s_add_u32 s44, s44, 4096
  s_waitcnt vmcnt(5)
  buffer_load_dwordx4 v[232:235], v1, s[8:11], s44 offen nt
  s_add_u32 s44, s44, 4096
  s_waitcnt vmcnt(5)
  buffer_load_dwordx4 v[236:239], v1, s[8:11], s44 offen nt
  s_add_u32 s44, s44, 4096
  s_waitcnt vmcnt(5)
  buffer_load_dwordx4 v[240:243], v1, s[8:11], s44 offen nt
  s_add_u32 s44, s44, 4096
  s_waitcnt vmcnt(5)
  buffer_load_dwordx4 v[244:247], v1, s[8:11], s44 offen nt
  s_add_u32 s44, s44, 4096
  s_waitcnt vmcnt(5)
  buffer_load_dwordx4 v[248:251], v1, s[8:11], s44 offen nt
  s_add_u32 s44, s44, 4096
  s_waitcnt vmcnt(5)
  buffer_load_dwordx4 v[252:255], v1, s[8:11], s44 offen nt
  s_add_u32 s44, s44, 4096
  s_waitcnt vmcnt(5)
  buffer_load_dwordx4 v[64:67], v1, s[8:11], s44 offen nt
  s_add_u32 s44, s44, 4096
  s_waitcnt vmcnt(5)
  buffer_load_dwordx4 v[68:71], v1, s[8:11], s44 offen nt
  s_add_u32 s44, s44, 4096
  s_waitcnt vmcnt(5)
  buffer_load_dwordx4 v[72:75], v1, s[8:11], s44 offen nt
  s_add_u32 s44, s44, 4096
  s_waitcnt vmcnt(5)
  buffer_load_dwordx4 v[76:79], v1, s[8:11], s44 offen nt
  s_add_u32 s44, s44, 4096
  s_waitcnt vmcnt(5)
  buffer_load_dwordx4 v[80:83], v1, s[8:11], s44 offen nt
  s_add_u32 s44, s44, 4096
  s_waitcnt vmcnt(5)
  buffer_load_dwordx4 v[84:87], v1, s[8:11], s44 offen nt
  s_add_u32 s44, s44, 4096
  s_waitcnt vmcnt(5)
  buffer_load_dwordx4 v[88:91], v1, s[8:11], s44 offen nt
  s_add_u32 s44, s44, 4096
  s_waitcnt vmcnt(5)
  buffer_load_dwordx4 v[92:95], v1, s[8:11], s44 offen nt
  s_add_u32 s44, s44, 4096
  s_barrier
  ds_read_b128 v[8:11], v50 offset:1024
  ds_read_b128 v[12:15], v50 offset:1040
  s_waitcnt lgkmcnt(0)
  v_cvt_pk_bf16_f32 v4, v8, v9
  v_cvt_pk_bf16_f32 v5, v10, v11
  v_cvt_pk_bf16_f32 v6, v12, v13
  v_cvt_pk_bf16_f32 v7, v14, v15
  s_waitcnt vmcnt(5)
  v_mov_b32 v8, 0
  v_dot2c_f32_bf16 v8, v64, v4
  v_dot2c_f32_bf16 v8, v65, v5
  v_dot2c_f32_bf16 v8, v66, v6
  v_dot2c_f32_bf16 v8, v67, v7
  buffer_load_dwordx4 v[64:67], v1, s[8:11], s44 offen nt
  s_add_u32 s44, s44, 4096
  v_mov_b32 v16, 0
  v_dot2c_f32_bf16 v16, v96, v4
  v_dot2c_f32_bf16 v16, v97, v5
  v_dot2c_f32_bf16 v16, v98, v6
  v_dot2c_f32_bf16 v16, v99, v7
  v_mov_b32 v17, 0
  v_dot2c_f32_bf16 v17, v100, v4
  v_dot2c_f32_bf16 v17, v101, v5
  v_dot2c_f32_bf16 v17, v102, v6
  v_dot2c_f32_bf16 v17, v103, v7
  v_mov_b32 v18, 0
  v_dot2c_f32_bf16 v18, v104, v4
  v_dot2c_f32_bf16 v18, v105, v5
  v_dot2c_f32_bf16 v18, v106, v6
  v_dot2c_f32_bf16 v18, v107, v7
  v_mov_b32 v19, 0
  v_dot2c_f32_bf16 v19, v108, v4
  v_dot2c_f32_bf16 v19, v109, v5
  v_dot2c_f32_bf16 v19, v110, v6
  v_dot2c_f32_bf16 v19, v111, v7
  v_mov_b32 v20, 0
  v_dot2c_f32_bf16 v20, v112, v4
  v_dot2c_f32_bf16 v20, v113, v5
  v_dot2c_f32_bf16 v20, v114, v6
  v_dot2c_f32_bf16 v20, v115, v7
  s_waitcnt vmcnt(5)
  v_mov_b32 v9, 0
  v_dot2c_f32_bf16 v9, v68, v4
  v_dot2c_f32_bf16 v9, v69, v5
  v_dot2c_f32_bf16 v9, v70, v6
  v_dot2c_f32_bf16 v9, v71, v7
  buffer_load_dwordx4 v[68:71], v1, s[8:11], s44 offen nt
  s_add_u32 s44, s44, 4096
  v_mov_b32 v21, 0
  v_dot2c_f32_bf16 v21, v116, v4
  v_dot2c_f32_bf16 v21, v117, v5
  v_dot2c_f32_bf16 v21, v118, v6
  v_dot2c_f32_bf16 v21, v119, v7
  v_mov_b32 v22, 0
  v_dot2c_f32_bf16 v22, v120, v4
  v_dot2c_f32_bf16 v22, v121, v5
  v_dot2c_f32_bf16 v22, v122, v6
  v_dot2c_f32_bf16 v22, v123, v7
  v_mov_b32 v23, 0
  v_dot2c_f32_bf16 v23, v124, v4
  v_dot2c_f32_bf16 v23, v125, v5
  v_dot2c_f32_bf16 v23, v126, v6
  v_dot2c_f32_bf16 v23, v127, v7
  s_nop 2
  v_add_f32_dpp v24, v16, v16 row_ror:8 row_mask:0xf bank_mask:0x3
  v_add_f32_dpp v24, v20, v20 row_ror:8 row_mask:0xf bank_mask:0xc
  v_add_f32_dpp v25, v17, v17 row_ror:8 row_mask:0xf bank_mask:0x3
  v_add_f32_dpp v25, v21, v21 row_ror:8 row_mask:0xf bank_mask:0xc
  v_add_f32_dpp v26, v18, v18 row_ror:8 row_mask:0xf bank_mask:0x3
  v_add_f32_dpp v26, v22, v22 row_ror:8 row_mask:0xf bank_mask:0xc
  v_add_f32_dpp v27, v19, v19 row_ror:8 row_mask:0xf bank_mask:0x3
  v_add_f32_dpp v27, v23, v23 row_ror:8 row_mask:0xf bank_mask:0xc
  v_add_f32_dpp v28, v24, v24 row_half_mirror row_mask:0xf bank_mask:0x5
  v_add_f32_dpp v28, v26, v26 row_half_mirror row_mask:0xf bank_mask:0xa
  v_add_f32_dpp v29, v25, v25 row_half_mirror row_mask:0xf bank_mask:0x5
  v_add_f32_dpp v29, v27, v27 row_half_mirror row_mask:0xf bank_mask:0xa
  s_nop 0
  v_add_f32_dpp v30, v28, v28 quad_perm:[2,3,0,1] row_mask:0xf bank_mask:0xf
  v_add_f32_dpp v31, v29, v29 quad_perm:[2,3,0,1] row_mask:0xf bank_mask:0xf
  v_cndmask_b32 v30, v30, v31, s[48:49]
  s_nop 1
  v_add_f32_dpp v30, v30, v30 quad_perm:[1,0,3,2] row_mask:0xf bank_mask:0xf
  v_cvt_pk_bf16_f32 v30, 0, v30
  v_mul_f32 v30, s47, v30
  v_cvt_pk_bf16_f32 v30, 0, v30
  ds_write_b32 v2, v30 offset:0
  v_max_f32 v24, v54, v30
  v_sub_f32 v25, v54, v24
  v_sub_f32 v26, v30, v24
  v_mul_f32 v25, s52, v25
  v_mul_f32 v26, s52, v26
  v_exp_f32 v25, v25
  v_exp_f32 v26, v26
  v_mov_b32 v54, v24
  s_nop 0
  v_fma_f32 v55, v55, v25, v26
  v_mov_b32 v16, 0
  v_dot2c_f32_bf16 v16, v128, v4
  v_dot2c_f32_bf16 v16, v129, v5
  v_dot2c_f32_bf16 v16, v130, v6
  v_dot2c_f32_bf16 v16, v131, v7
  v_mov_b32 v17, 0
  v_dot2c_f32_bf16 v17, v132, v4
  v_dot2c_f32_bf16 v17, v133, v5
  v_dot2c_f32_bf16 v17, v134, v6
  v_dot2c_f32_bf16 v17, v135, v7
  s_waitcnt vmcnt(5)
  v_mov_b32 v10, 0
  v_dot2c_f32_bf16 v10, v72, v4
  v_dot2c_f32_bf16 v10, v73, v5
  v_dot2c_f32_bf16 v10, v74, v6
  v_dot2c_f32_bf16 v10, v75, v7
  buffer_load_dwordx4 v[72:75], v1, s[8:11], s44 offen nt
  s_add_u32 s44, s44, 4096
  v_mov_b32 v18, 0
  v_dot2c_f32_bf16 v18, v136, v4
  v_dot2c_f32_bf16 v18, v137, v5
  v_dot2c_f32_bf16 v18, v138, v6
  v_dot2c_f32_bf16 v18, v139, v7
  v_mov_b32 v19, 0
  v_dot2c_f32_bf16 v19, v140, v4
  v_dot2c_f32_bf16 v19, v141, v5
  v_dot2c_f32_bf16 v19, v142, v6
  v_dot2c_f32_bf16 v19, v143, v7
  v_mov_b32 v20, 0
  v_dot2c_f32_bf16 v20, v144, v4
  v_dot2c_f32_bf16 v20, v145, v5
  v_dot2c_f32_bf16 v20, v146, v6
  v_dot2c_f32_bf16 v20, v147, v7
  v_mov_b32 v21, 0
  v_dot2c_f32_bf16 v21, v148, v4
  v_dot2c_f32_bf16 v21, v149, v5
  v_dot2c_f32_bf16 v21, v150, v6
  v_dot2c_f32_bf16 v21, v151, v7
  v_mov_b32 v22, 0
  v_dot2c_f32_bf16 v22, v152, v4
  v_dot2c_f32_bf16 v22, v153, v5
  v_dot2c_f32_bf16 v22, v154, v6
  v_dot2c_f32_bf16 v22, v155, v7
  s_waitcnt vmcnt(5)
  v_mov_b32 v11, 0
  v_dot2c_f32_bf16 v11, v76, v4
  v_dot2c_f32_bf16 v11, v77, v5
  v_dot2c_f32_bf16 v11, v78, v6
  v_dot2c_f32_bf16 v11, v79, v7
  buffer_load_dwordx4 v[76:79], v1, s[8:11], s44 offen nt
  s_add_u32 s44, s44, 4096
  v_mov_b32 v23, 0
  v_dot2c_f32_bf16 v23, v156, v4
  v_dot2c_f32_bf16 v23, v157, v5
  v_dot2c_f32_bf16 v23, v158, v6
  v_dot2c_f32_bf16 v23, v159, v7
  s_nop 2
  v_add_f32_dpp v24, v16, v16 row_ror:8 row_mask:0xf bank_mask:0x3
  v_add_f32_dpp v24, v20, v20 row_ror:8 row_mask:0xf bank_mask:0xc
  v_add_f32_dpp v25, v17, v17 row_ror:8 row_mask:0xf bank_mask:0x3
  v_add_f32_dpp v25, v21, v21 row_ror:8 row_mask:0xf bank_mask:0xc
  v_add_f32_dpp v26, v18, v18 row_ror:8 row_mask:0xf bank_mask:0x3
  v_add_f32_dpp v26, v22, v22 row_ror:8 row_mask:0xf bank_mask:0xc
  v_add_f32_dpp v27, v19, v19 row_ror:8 row_mask:0xf bank_mask:0x3
  v_add_f32_dpp v27, v23, v23 row_ror:8 row_mask:0xf bank_mask:0xc
  v_add_f32_dpp v28, v24, v24 row_half_mirror row_mask:0xf bank_mask:0x5
  v_add_f32_dpp v28, v26, v26 row_half_mirror row_mask:0xf bank_mask:0xa
  v_add_f32_dpp v29, v25, v25 row_half_mirror row_mask:0xf bank_mask:0x5
  v_add_f32_dpp v29, v27, v27 row_half_mirror row_mask:0xf bank_mask:0xa
  s_nop 0
  v_add_f32_dpp v30, v28, v28 quad_perm:[2,3,0,1] row_mask:0xf bank_mask:0xf
  v_add_f32_dpp v31, v29, v29 quad_perm:[2,3,0,1] row_mask:0xf bank_mask:0xf
  v_cndmask_b32 v30, v30, v31, s[48:49]
  s_nop 1
  v_add_f32_dpp v30, v30, v30 quad_perm:[1,0,3,2] row_mask:0xf bank_mask:0xf
  v_cvt_pk_bf16_f32 v30, 0, v30
  v_mul_f32 v30, s47, v30
  v_cvt_pk_bf16_f32 v30, 0, v30
  ds_write_b32 v2, v30 offset:128
  v_max_f32 v24, v54, v30
  v_sub_f32 v25, v54, v24
  v_sub_f32 v26, v30, v24
  v_mul_f32 v25, s52, v25
  v_mul_f32 v26, s52, v26
  v_exp_f32 v25, v25
  v_exp_f32 v26, v26
  v_mov_b32 v54, v24
  s_nop 0
  v_fma_f32 v55, v55, v25, v26
  v_mov_b32 v16, 0
  v_dot2c_f32_bf16 v16, v160, v4
  v_dot2c_f32_bf16 v16, v161, v5
  v_dot2c_f32_bf16 v16, v162, v6
  v_dot2c_f32_bf16 v16, v163, v7
  v_mov_b32 v17, 0
  v_dot2c_f32_bf16 v17, v164, v4
  v_dot2c_f32_bf16 v17, v165, v5
  v_dot2c_f32_bf16 v17, v166, v6
  v_dot2c_f32_bf16 v17, v167, v7
  v_mov_b32 v18, 0
  v_dot2c_f32_bf16 v18, v168, v4
  v_dot2c_f32_bf16 v18, v169, v5
  v_dot2c_f32_bf16 v18, v170, v6
  v_dot2c_f32_bf16 v18, v171, v7
  v_mov_b32 v19, 0
  v_dot2c_f32_bf16 v19, v172, v4
  v_dot2c_f32_bf16 v19, v173, v5
  v_dot2c_f32_bf16 v19, v174, v6
  v_dot2c_f32_bf16 v19, v175, v7
  s_waitcnt vmcnt(5)
  v_mov_b32 v12, 0
  v_dot2c_f32_bf16 v12, v80, v4
  v_dot2c_f32_bf16 v12, v81, v5
  v_dot2c_f32_bf16 v12, v82, v6
  v_dot2c_f32_bf16 v12, v83, v7
  buffer_load_dwordx4 v[80:83], v1, s[8:11], s44 offen nt
  s_add_u32 s44, s44, 4096
  v_mov_b32 v20, 0
  v_dot2c_f32_bf16 v20, v176, v4
  v_dot2c_f32_bf16 v20, v177, v5
  v_dot2c_f32_bf16 v20, v178, v6
  v_dot2c_f32_bf16 v20, v179, v7
  v_mov_b32 v21, 0
  v_dot2c_f32_bf16 v21, v180, v4
  v_dot2c_f32_bf16 v21, v181, v5
  v_dot2c_f32_bf16 v21, v182, v6
  v_dot2c_f32_bf16 v21, v183, v7
  v_mov_b32 v22, 0
  v_dot2c_f32_bf16 v22, v184, v4
  v_dot2c_f32_bf16 v22, v185, v5
  v_dot2c_f32_bf16 v22, v186, v6
  v_dot2c_f32_bf16 v22, v187, v7
  v_mov_b32 v23, 0
  v_dot2c_f32_bf16 v23, v188, v4
  v_dot2c_f32_bf16 v23, v189, v5
  v_dot2c_f32_bf16 v23, v190, v6
  v_dot2c_f32_bf16 v23, v191, v7
  s_nop 2
  v_add_f32_dpp v24, v16, v16 row_ror:8 row_mask:0xf bank_mask:0x3
  v_add_f32_dpp v24, v20, v20 row_ror:8 row_mask:0xf bank_mask:0xc
  v_add_f32_dpp v25, v17, v17 row_ror:8 row_mask:0xf bank_mask:0x3
  v_add_f32_dpp v25, v21, v21 row_ror:8 row_mask:0xf bank_mask:0xc
  v_add_f32_dpp v26, v18, v18 row_ror:8 row_mask:0xf bank_mask:0x3
  v_add_f32_dpp v26, v22, v22 row_ror:8 row_mask:0xf bank_mask:0xc
  v_add_f32_dpp v27, v19, v19 row_ror:8 row_mask:0xf bank_mask:0x3
  v_add_f32_dpp v27, v23, v23 row_ror:8 row_mask:0xf bank_mask:0xc
  v_add_f32_dpp v28, v24, v24 row_half_mirror row_mask:0xf bank_mask:0x5
  v_add_f32_dpp v28, v26, v26 row_half_mirror row_mask:0xf bank_mask:0xa
  v_add_f32_dpp v29, v25, v25 row_half_mirror row_mask:0xf bank_mask:0x5
  v_add_f32_dpp v29, v27, v27 row_half_mirror row_mask:0xf bank_mask:0xa
  s_nop 0
  v_add_f32_dpp v30, v28, v28 quad_perm:[2,3,0,1] row_mask:0xf bank_mask:0xf
  v_add_f32_dpp v31, v29, v29 quad_perm:[2,3,0,1] row_mask:0xf bank_mask:0xf
  v_cndmask_b32 v30, v30, v31, s[48:49]
  s_nop 1
  v_add_f32_dpp v30, v30, v30 quad_perm:[1,0,3,2] row_mask:0xf bank_mask:0xf
  v_cvt_pk_bf16_f32 v30, 0, v30
  v_mul_f32 v30, s47, v30
  v_cvt_pk_bf16_f32 v30, 0, v30
  ds_write_b32 v2, v30 offset:256
  v_max_f32 v24, v54, v30
  v_sub_f32 v25, v54, v24
  v_sub_f32 v26, v30, v24
  v_mul_f32 v25, s52, v25
  v_mul_f32 v26, s52, v26
  v_exp_f32 v25, v25
  v_exp_f32 v26, v26
  v_mov_b32 v54, v24
  s_nop 0
  v_fma_f32 v55, v55, v25, v26
  v_mov_b32 v16, 0
  v_dot2c_f32_bf16 v16, v192, v4
  v_dot2c_f32_bf16 v16, v193, v5
  v_dot2c_f32_bf16 v16, v194, v6
  v_dot2c_f32_bf16 v16, v195, v7
  s_waitcnt vmcnt(5)
  v_mov_b32 v13, 0
  v_dot2c_f32_bf16 v13, v84, v4
  v_dot2c_f32_bf16 v13, v85, v5
  v_dot2c_f32_bf16 v13, v86, v6
  v_dot2c_f32_bf16 v13, v87, v7
  buffer_load_dwordx4 v[84:87], v1, s[8:11], s44 offen nt
  s_add_u32 s44, s44, 4096
  v_mov_b32 v17, 0
  v_dot2c_f32_bf16 v17, v196, v4
  v_dot2c_f32_bf16 v17, v197, v5
  v_dot2c_f32_bf16 v17, v198, v6
  v_dot2c_f32_bf16 v17, v199, v7
  v_mov_b32 v18, 0
  v_dot2c_f32_bf16 v18, v200, v4
  v_dot2c_f32_bf16 v18, v201, v5
  v_dot2c_f32_bf16 v18, v202, v6
  v_dot2c_f32_bf16 v18, v203, v7
  v_mov_b32 v19, 0
  v_dot2c_f32_bf16 v19, v204, v4
  v_dot2c_f32_bf16 v19, v205, v5
  v_dot2c_f32_bf16 v19, v206, v6
  v_dot2c_f32_bf16 v19, v207, v7
  v_mov_b32 v20, 0
  v_dot2c_f32_bf16 v20, v208, v4
  v_dot2c_f32_bf16 v20, v209, v5
  v_dot2c_f32_bf16 v20, v210, v6
  v_dot2c_f32_bf16 v20, v211, v7
  v_mov_b32 v21, 0
  v_dot2c_f32_bf16 v21, v212, v4
  v_dot2c_f32_bf16 v21, v213, v5
  v_dot2c_f32_bf16 v21, v214, v6
  v_dot2c_f32_bf16 v21, v215, v7
  s_waitcnt vmcnt(5)
  v_mov_b32 v14, 0
  v_dot2c_f32_bf16 v14, v88, v4
  v_dot2c_f32_bf16 v14, v89, v5
  v_dot2c_f32_bf16 v14, v90, v6
  v_dot2c_f32_bf16 v14, v91, v7
  buffer_load_dwordx4 v[88:91], v1, s[8:11], s44 offen nt
  s_add_u32 s44, s44, 4096
  v_mov_b32 v22, 0
  v_dot2c_f32_bf16 v22, v216, v4
  v_dot2c_f32_bf16 v22, v217, v5
  v_dot2c_f32_bf16 v22, v218, v6
  v_dot2c_f32_bf16 v22, v219, v7
  v_mov_b32 v23, 0
  v_dot2c_f32_bf16 v23, v220, v4
  v_dot2c_f32_bf16 v23, v221, v5
  v_dot2c_f32_bf16 v23, v222, v6
  v_dot2c_f32_bf16 v23, v223, v7
  s_nop 2
  v_add_f32_dpp v24, v16, v16 row_ror:8 row_mask:0xf bank_mask:0x3
  v_add_f32_dpp v24, v20, v20 row_ror:8 row_mask:0xf bank_mask:0xc
  v_add_f32_dpp v25, v17, v17 row_ror:8 row_mask:0xf bank_mask:0x3
  v_add_f32_dpp v25, v21, v21 row_ror:8 row_mask:0xf bank_mask:0xc
  v_add_f32_dpp v26, v18, v18 row_ror:8 row_mask:0xf bank_mask:0x3
  v_add_f32_dpp v26, v22, v22 row_ror:8 row_mask:0xf bank_mask:0xc
  v_add_f32_dpp v27, v19, v19 row_ror:8 row_mask:0xf bank_mask:0x3
  v_add_f32_dpp v27, v23, v23 row_ror:8 row_mask:0xf bank_mask:0xc
  v_add_f32_dpp v28, v24, v24 row_half_mirror row_mask:0xf bank_mask:0x5
  v_add_f32_dpp v28, v26, v26 row_half_mirror row_mask:0xf bank_mask:0xa
  v_add_f32_dpp v29, v25, v25 row_half_mirror row_mask:0xf bank_mask:0x5
  v_add_f32_dpp v29, v27, v27 row_half_mirror row_mask:0xf bank_mask:0xa
  s_nop 0
  v_add_f32_dpp v30, v28, v28 quad_perm:[2,3,0,1] row_mask:0xf bank_mask:0xf
  v_add_f32_dpp v31, v29, v29 quad_perm:[2,3,0,1] row_mask:0xf bank_mask:0xf
  v_cndmask_b32 v30, v30, v31, s[48:49]
  s_nop 1
  v_add_f32_dpp v30, v30, v30 quad_perm:[1,0,3,2] row_mask:0xf bank_mask:0xf
  v_cvt_pk_bf16_f32 v30, 0, v30
  v_mul_f32 v30, s47, v30
  v_cvt_pk_bf16_f32 v30, 0, v30
  ds_write_b32 v2, v30 offset:384
  v_max_f32 v24, v54, v30
  v_sub_f32 v25, v54, v24
  v_sub_f32 v26, v30, v24
  v_mul_f32 v25, s52, v25
  v_mul_f32 v26, s52, v26
  v_exp_f32 v25, v25
  v_exp_f32 v26, v26
  v_mov_b32 v54, v24
  s_nop 0
  v_fma_f32 v55, v55, v25, v26
  v_mov_b32 v16, 0
  v_dot2c_f32_bf16 v16, v224, v4
  v_dot2c_f32_bf16 v16, v225, v5
  v_dot2c_f32_bf16 v16, v226, v6
  v_dot2c_f32_bf16 v16, v227, v7
  v_mov_b32 v17, 0
  v_dot2c_f32_bf16 v17, v228, v4
  v_dot2c_f32_bf16 v17, v229, v5
  v_dot2c_f32_bf16 v17, v230, v6
  v_dot2c_f32_bf16 v17, v231, v7
  v_mov_b32 v18, 0
  v_dot2c_f32_bf16 v18, v232, v4
  v_dot2c_f32_bf16 v18, v233, v5
  v_dot2c_f32_bf16 v18, v234, v6
  v_dot2c_f32_bf16 v18, v235, v7
  s_waitcnt vmcnt(5)
  v_mov_b32 v15, 0
  v_dot2c_f32_bf16 v15, v92, v4
  v_dot2c_f32_bf16 v15, v93, v5
  v_dot2c_f32_bf16 v15, v94, v6
  v_dot2c_f32_bf16 v15, v95, v7
  buffer_load_dwordx4 v[92:95], v1, s[8:11], s44 offen nt
  s_add_u32 s44, s44, 4096
  v_mov_b32 v19, 0
  v_dot2c_f32_bf16 v19, v236, v4
  v_dot2c_f32_bf16 v19, v237, v5
  v_dot2c_f32_bf16 v19, v238, v6
  v_dot2c_f32_bf16 v19, v239, v7
  v_mov_b32 v20, 0
  v_dot2c_f32_bf16 v20, v240, v4
  v_dot2c_f32_bf16 v20, v241, v5
  v_dot2c_f32_bf16 v20, v242, v6
  v_dot2c_f32_bf16 v20, v243, v7
  v_mov_b32 v21, 0
  v_dot2c_f32_bf16 v21, v244, v4
  v_dot2c_f32_bf16 v21, v245, v5
  v_dot2c_f32_bf16 v21, v246, v6
  v_dot2c_f32_bf16 v21, v247, v7
  v_mov_b32 v22, 0
  v_dot2c_f32_bf16 v22, v248, v4
  v_dot2c_f32_bf16 v22, v249, v5
  v_dot2c_f32_bf16 v22, v250, v6
  v_dot2c_f32_bf16 v22, v251, v7
  v_mov_b32 v23, 0
  v_dot2c_f32_bf16 v23, v252, v4
  v_dot2c_f32_bf16 v23, v253, v5
  v_dot2c_f32_bf16 v23, v254, v6
  v_dot2c_f32_bf16 v23, v255, v7
  s_nop 2
  v_add_f32_dpp v24, v16, v16 row_ror:8 row_mask:0xf bank_mask:0x3
  v_add_f32_dpp v24, v20, v20 row_ror:8 row_mask:0xf bank_mask:0xc
  v_add_f32_dpp v25, v17, v17 row_ror:8 row_mask:0xf bank_mask:0x3
  v_add_f32_dpp v25, v21, v21 row_ror:8 row_mask:0xf bank_mask:0xc
  v_add_f32_dpp v26, v18, v18 row_ror:8 row_mask:0xf bank_mask:0x3
  v_add_f32_dpp v26, v22, v22 row_ror:8 row_mask:0xf bank_mask:0xc
  v_add_f32_dpp v27, v19, v19 row_ror:8 row_mask:0xf bank_mask:0x3
  v_add_f32_dpp v27, v23, v23 row_ror:8 row_mask:0xf bank_mask:0xc
  v_add_f32_dpp v28, v24, v24 row_half_mirror row_mask:0xf bank_mask:0x5
  v_add_f32_dpp v28, v26, v26 row_half_mirror row_mask:0xf bank_mask:0xa
  v_add_f32_dpp v29, v25, v25 row_half_mirror row_mask:0xf bank_mask:0x5
  v_add_f32_dpp v29, v27, v27 row_half_mirror row_mask:0xf bank_mask:0xa
  s_nop 0
  v_add_f32_dpp v30, v28, v28 quad_perm:[2,3,0,1] row_mask:0xf bank_mask:0xf
  v_add_f32_dpp v31, v29, v29 quad_perm:[2,3,0,1] row_mask:0xf bank_mask:0xf
  v_cndmask_b32 v30, v30, v31, s[48:49]
  s_nop 1
  v_add_f32_dpp v30, v30, v30 quad_perm:[1,0,3,2] row_mask:0xf bank_mask:0xf
  v_cvt_pk_bf16_f32 v30, 0, v30
  v_mul_f32 v30, s47, v30
  v_cvt_pk_bf16_f32 v30, 0, v30
  ds_write_b32 v2, v30 offset:512
  v_max_f32 v24, v54, v30
  v_sub_f32 v25, v54, v24
  v_sub_f32 v26, v30, v24
  v_mul_f32 v25, s52, v25
  v_mul_f32 v26, s52, v26
  v_exp_f32 v25, v25
  v_exp_f32 v26, v26
  v_mov_b32 v54, v24
  s_nop 0
  v_fma_f32 v55, v55, v25, v26
  ds_read_b32 v57, v56
  v_add_u32 v2, 640, v2
  s_nop 2
  v_add_f32_dpp v24, v8, v8 row_ror:8 row_mask:0xf bank_mask:0x3
  v_add_f32_dpp v24, v12, v12 row_ror:8 row_mask:0xf bank_mask:0xc
  v_add_f32_dpp v25, v9, v9 row_ror:8 row_mask:0xf bank_mask:0x3
  v_add_f32_dpp v25, v13, v13 row_ror:8 row_mask:0xf bank_mask:0xc
  v_add_f32_dpp v26, v10, v10 row_ror:8 row_mask:0xf bank_mask:0x3
  v_add_f32_dpp v26, v14, v14 row_ror:8 row_mask:0xf bank_mask:0xc
  v_add_f32_dpp v27, v11, v11 row_ror:8 row_mask:0xf bank_mask:0x3
  v_add_f32_dpp v27, v15, v15 row_ror:8 row_mask:0xf bank_mask:0xc
  v_add_f32_dpp v28, v24, v24 row_half_mirror row_mask:0xf bank_mask:0x5
  v_add_f32_dpp v28, v26, v26 row_half_mirror row_mask:0xf bank_mask:0xa
  v_add_f32_dpp v29, v25, v25 row_half_mirror row_mask:0xf bank_mask:0x5
  v_add_f32_dpp v29, v27, v27 row_half_mirror row_mask:0xf bank_mask:0xa
  s_nop 0
  v_add_f32_dpp v30, v28, v28 quad_perm:[2,3,0,1] row_mask:0xf bank_mask:0xf
  v_add_f32_dpp v31, v29, v29 quad_perm:[2,3,0,1] row_mask:0xf bank_mask:0xf
  v_cndmask_b32 v30, v30, v31, s[48:49]
  s_nop 1
  v_add_f32_dpp v30, v30, v30 quad_perm:[1,0,3,2] row_mask:0xf bank_mask:0xf
  v_cvt_pk_bf16_f32 v30, 0, v30
  v_mul_f32 v30, s47, v30
  v_cvt_pk_bf16_f32 v30, 0, v30
  ds_write_b32 v2, v30
  v_max_f32 v24, v54, v30
  v_sub_f32 v25, v54, v24
  v_sub_f32 v26, v30, v24
  v_mul_f32 v25, s52, v25
  v_mul_f32 v26, s52, v26
  v_exp_f32 v25, v25
  v_exp_f32 v26, v26
  v_mov_b32 v54, v24
  v_add_u32 v2, 128, v2
  v_fma_f32 v55, v55, v25, v26
L_k_top:
  s_waitcnt lgkmcnt(0)
  v_readfirstlane_b32 s50, v57
  s_nop 0
  s_cmp_ge_u32 s50, 0xfffffffe
  s_cbranch_scc1 L_k_slow
  s_add_u32 s44, s50, s53
  v_add_u32 v56, 4, v56
  ds_write_b32 v58, v59 offset:96
  v_add_u32 v59, 1, v59
  s_waitcnt vmcnt(5)
  v_mov_b32 v8, 0
  v_dot2c_f32_bf16 v8, v64, v4
  v_dot2c_f32_bf16 v8, v65, v5
  v_dot2c_f32_bf16 v8, v66, v6
  v_dot2c_f32_bf16 v8, v67, v7
  buffer_load_dwordx4 v[64:67], v1, s[8:11], s44 offen nt
  s_add_u32 s44, s44, 4096
  s_waitcnt vmcnt(5)
  v_mov_b32 v9, 0
  v_dot2c_f32_bf16 v9, v68, v4
  v_dot2c_f32_bf16 v9, v69, v5
  v_dot2c_f32_bf16 v9, v70, v6
  v_dot2c_f32_bf16 v9, v71, v7
  buffer_load_dwordx4 v[68:71], v1, s[8:11], s44 offen nt
  s_add_u32 s44, s44, 4096
  s_waitcnt vmcnt(5)
  v_mov_b32 v10, 0
  v_dot2c_f32_bf16 v10, v72, v4
  v_dot2c_f32_bf16 v10, v73, v5
  v_dot2c_f32_bf16 v10, v74, v6
  v_dot2c_f32_bf16 v10, v75, v7
  buffer_load_dwordx4 v[72:75], v1, s[8:11], s44 offen nt
  s_add_u32 s44, s44, 4096
  s_waitcnt vmcnt(5)
  v_mov_b32 v11, 0
  v_dot2c_f32_bf16 v11, v76, v4
  v_dot2c_f32_bf16 v11, v77, v5
  v_dot2c_f32_bf16 v11, v78, v6
  v_dot2c_f32_bf16 v11, v79, v7
  buffer_load_dwordx4 v[76:79], v1, s[8:11], s44 offen nt
  s_add_u32 s44, s44, 4096
  s_waitcnt vmcnt(5)
  v_mov_b32 v12, 0
  v_dot2c_f32_bf16 v12, v80, v4
  v_dot2c_f32_bf16 v12, v81, v5
  v_dot2c_f32_bf16 v12, v82, v6
  v_dot2c_f32_bf16 v12, v83, v7
  buffer_load_dwordx4 v[80:83], v1, s[8:11], s44 offen nt
  s_add_u32 s44, s44, 4096
  s_waitcnt vmcnt(5)
  v_mov_b32 v13, 0
  v_dot2c_f32_bf16 v13, v84, v4
  v_dot2c_f32_bf16 v13, v85, v5
  v_dot2c_f32_bf16 v13, v86, v6
  v_dot2c_f32_bf16 v13, v87, v7
  buffer_load_dwordx4 v[84:87], v1, s[8:11], s44 offen nt
  s_add_u32 s44, s44, 4096
  s_waitcnt vmcnt(5)
  v_mov_b32 v14, 0
  v_dot2c_f32_bf16 v14, v88, v4
  v_dot2c_f32_bf16 v14, v89, v5
  v_dot2c_f32_bf16 v14, v90, v6
  v_dot2c_f32_bf16 v14, v91, v7
  buffer_load_dwordx4 v[88:91], v1, s[8:11], s44 offen nt
  s_add_u32 s44, s44, 4096
  ds_read_b32 v57, v56
  s_waitcnt vmcnt(5)
  v_mov_b32 v15, 0
  v_dot2c_f32_bf16 v15, v92, v4
  v_dot2c_f32_bf16 v15, v93, v5
  v_dot2c_f32_bf16 v15, v94, v6
  v_dot2c_f32_bf16 v15, v95, v7
  buffer_load_dwordx4 v[92:95], v1, s[8:11], s44 offen nt
  s_add_u32 s44, s44, 4096
  s_nop 2
  v_add_f32_dpp v24, v8, v8 row_ror:8 row_mask:0xf bank_mask:0x3
  v_add_f32_dpp v24, v12, v12 row_ror:8 row_mask:0xf bank_mask:0xc
  v_add_f32_dpp v25, v9, v9 row_ror:8 row_mask:0xf bank_mask:0x3
  v_add_f32_dpp v25, v13, v13 row_ror:8 row_mask:0xf bank_mask:0xc
  v_add_f32_dpp v26, v10, v10 row_ror:8 row_mask:0xf bank_mask:0x3
  v_add_f32_dpp v26, v14, v14 row_ror:8 row_mask:0xf bank_mask:0xc
  v_add_f32_dpp v27, v11, v11 row_ror:8 row_mask:0xf bank_mask:0x3
  v_add_f32_dpp v27, v15, v15 row_ror:8 row_mask:0xf bank_mask:0xc
  v_add_f32_dpp v28, v24, v24 row_half_mirror row_mask:0xf bank_mask:0x5
  v_add_f32_dpp v28, v26, v26 row_half_mirror row_mask:0xf bank_mask:0xa
  v_add_f32_dpp v29, v25, v25 row_half_mirror row_mask:0xf bank_mask:0x5
  v_add_f32_dpp v29, v27, v27 row_half_mirror row_mask:0xf bank_mask:0xa
  s_nop 0
  v_add_f32_dpp v30, v28, v28 quad_perm:[2,3,0,1] row_mask:0xf bank_mask:0xf
  v_add_f32_dpp v31, v29, v29 quad_perm:[2,3,0,1] row_mask:0xf bank_mask:0xf
  v_cndmask_b32 v30, v30, v31, s[48:49]
  s_nop 1
  v_add_f32_dpp v30, v30, v30 quad_perm:[1,0,3,2] row_mask:0xf bank_mask:0xf
  v_cvt_pk_bf16_f32 v30, 0, v30
  v_mul_f32 v30, s47, v30
  v_cvt_pk_bf16_f32 v30, 0, v30
  ds_write_b32 v2, v30
  v_max_f32 v24, v54, v30
  v_sub_f32 v25, v54, v24
  v_sub_f32 v26, v30, v24
  v_mul_f32 v25, s52, v25
  v_mul_f32 v26, s52, v26
  v_exp_f32 v25, v25
  v_exp_f32 v26, v26
  v_mov_b32 v54, v24
  v_add_u32 v2, 128, v2
  v_fma_f32 v55, v55, v25, v26
  s_branch L_k_top
L_k_slow:
  s_cmp_eq_u32 s50, 0xfffffffe
  s_cbranch_scc1 L_k_last
  s_sub_u32 s70, s70, 1
  s_cmp_eq_u32 s70, 0
  s_cbranch_scc1 L_k_last
  s_sleep 1
  ds_read_b32 v57, v56
  s_branch L_k_top
L_k_last:
  s_mov_b32 s44, s45
  s_waitcnt vmcnt(5)
  v_mov_b32 v8, 0
  v_dot2c_f32_bf16 v8, v64, v4
  v_dot2c_f32_bf16 v8, v65, v5
  v_dot2c_f32_bf16 v8, v66, v6
  v_dot2c_f32_bf16 v8, v67, v7
  buffer_load_dwordx4 v[96:99], v1, s[12:15], s44 offen nt
  s_add_u32 s44, s44, 4096
  s_waitcnt vmcnt(5)
  v_mov_b32 v9, 0
  v_dot2c_f32_bf16 v9, v68, v4
  v_dot2c_f32_bf16 v9, v69, v5
  v_dot2c_f32_bf16 v9, v70, v6
  v_dot2c_f32_bf16 v9, v71, v7
  buffer_load_dwordx4 v[100:103], v1, s[12:15], s44 offen nt
  s_add_u32 s44, s44, 4096
  s_waitcnt vmcnt(5)
  v_mov_b32 v10, 0
  v_dot2c_f32_bf16 v10, v72, v4
  v_dot2c_f32_bf16 v10, v73, v5
  v_dot2c_f32_bf16 v10, v74, v6
  v_dot2c_f32_bf16 v10, v75, v7
  buffer_load_dwordx4 v[104:107], v1, s[12:15], s44 offen nt
  s_add_u32 s44, s44, 4096
  s_waitcnt vmcnt(5)
  v_mov_b32 v11, 0
  v_dot2c_f32_bf16 v11, v76, v4
  v_dot2c_f32_bf16 v11, v77, v5
  v_dot2c_f32_bf16 v11, v78, v6
  v_dot2c_f32_bf16 v11, v79, v7
  buffer_load_dwordx4 v[108:111], v1, s[12:15], s44 offen nt
  s_add_u32 s44, s44, 4096
  s_waitcnt vmcnt(5)
  v_mov_b32 v12, 0
  v_dot2c_f32_bf16 v12, v80, v4
  v_dot2c_f32_bf16 v12, v81, v5
  v_dot2c_f32_bf16 v12, v82, v6
  v_dot2c_f32_bf16 v12, v83, v7
  buffer_load_dwordx4 v[112:115], v1, s[12:15], s44 offen nt
  s_add_u32 s44, s44, 4096
  s_waitcnt vmcnt(5)
  v_mov_b32 v13, 0
  v_dot2c_f32_bf16 v13, v84, v4
  v_dot2c_f32_bf16 v13, v85, v5
  v_dot2c_f32_bf16 v13, v86, v6
  v_dot2c_f32_bf16 v13, v87, v7
  buffer_load_dwordx4 v[116:119], v1, s[12:15], s44 offen nt
  s_add_u32 s44, s44, 4096
  s_waitcnt vmcnt(5)
  v_mov_b32 v14, 0
  v_dot2c_f32_bf16 v14, v88, v4
  v_dot2c_f32_bf16 v14, v89, v5
  v_dot2c_f32_bf16 v14, v90, v6
  v_dot2c_f32_bf16 v14, v91, v7
  buffer_load_dwordx4 v[120:123], v1, s[12:15], s44 offen nt
  s_add_u32 s44, s44, 4096
  s_waitcnt vmcnt(5)
  v_mov_b32 v15, 0
  v_dot2c_f32_bf16 v15, v92, v4
  v_dot2c_f32_bf16 v15, v93, v5
  v_dot2c_f32_bf16 v15, v94, v6
  v_dot2c_f32_bf16 v15, v95, v7
  buffer_load_dwordx4 v[124:127], v1, s[12:15], s44 offen nt
  s_add_u32 s44, s44, 4096
  s_nop 2
  v_add_f32_dpp v24, v8, v8 row_ror:8 row_mask:0xf bank_mask:0x3
  v_add_f32_dpp v24, v12, v12 row_ror:8 row_mask:0xf bank_mask:0xc
  v_add_f32_dpp v25, v9, v9 row_ror:8 row_mask:0xf bank_mask:0x3
  v_add_f32_dpp v25, v13, v13 row_ror:8 row_mask:0xf bank_mask:0xc
  v_add_f32_dpp v26, v10, v10 row_ror:8 row_mask:0xf bank_mask:0x3
  v_add_f32_dpp v26, v14, v14 row_ror:8 row_mask:0xf bank_mask:0xc
  v_add_f32_dpp v27, v11, v11 row_ror:8 row_mask:0xf bank_mask:0x3
  v_add_f32_dpp v27, v15, v15 row_ror:8 row_mask:0xf bank_mask:0xc
  v_add_f32_dpp v28, v24, v24 row_half_mirror row_mask:0xf bank_mask:0x5
  v_add_f32_dpp v28, v26, v26 row_half_mirror row_mask:0xf bank_mask:0xa
  v_add_f32_dpp v29, v25, v25 row_half_mirror row_mask:0xf bank_mask:0x5
  v_add_f32_dpp v29, v27, v27 row_half_mirror row_mask:0xf bank_mask:0xa
  s_nop 0
  v_add_f32_dpp v30, v28, v28 quad_perm:[2,3,0,1] row_mask:0xf bank_mask:0xf
  v_add_f32_dpp v31, v29, v29 quad_perm:[2,3,0,1] row_mask:0xf bank_mask:0xf
  v_cndmask_b32 v30, v30, v31, s[48:49]
  s_nop 1
  v_add_f32_dpp v30, v30, v30 quad_perm:[1,0,3,2] row_mask:0xf bank_mask:0xf
  v_cvt_pk_bf16_f32 v30, 0, v30
  v_mul_f32 v30, s47, v30
  v_cvt_pk_bf16_f32 v30, 0, v30
  ds_write_b32 v2, v30
  v_max_f32 v24, v54, v30
  v_sub_f32 v25, v54, v24
  v_sub_f32 v26, v30, v24
  v_mul_f32 v25, s52, v25
  v_mul_f32 v26, s52, v26
  v_exp_f32 v25, v25
  v_exp_f32 v26, v26
  v_mov_b32 v54, v24
  v_add_u32 v2, 128, v2
  v_fma_f32 v55, v55, v25, v26
  v_mov_b32 v24, v54
  s_nop 1
  v_max_f32_dpp v24, v24, v24 row_ror:8 row_mask:0xf bank_mask:0xf
  s_nop 1
  v_max_f32_dpp v24, v24, v24 row_ror:4 row_mask:0xf bank_mask:0xf
  s_nop 1
  v_max_f32_dpp v24, v24, v24 row_ror:2 row_mask:0xf bank_mask:0xf
  s_nop 1
  v_max_f32_dpp v24, v24, v24 row_ror:1 row_mask:0xf bank_mask:0xf
  v_mov_b32 v25, v24
  s_nop 1
  v_permlane16_swap_b32 v24, v25
  v_max_f32 v24, v24, v25
  v_mov_b32 v25, v24
  s_nop 1
  v_permlane32_swap_b32 v24, v25
  v_max_f32 v24, v24, v25
  v_sub_f32 v26, v54, v24
  v_mul_f32 v26, s52, v26
  v_exp_f32 v26, v26
  ds_read_b32 v27, v58 offset:256
  s_lshl_b32 s50, s2, 6
  s_lshl_b32 s56, s6, 4
  s_add_u32 s50, s50, s56
  v_mul_f32 v26, v26, v55
  s_nop 1
  v_add_f32_dpp v26, v26, v26 row_ror:8 row_mask:0xf bank_mask:0xf
  s_nop 1
  v_add_f32_dpp v26, v26, v26 row_ror:4 row_mask:0xf bank_mask:0xf
  s_nop 1
  v_add_f32_dpp v26, v26, v26 row_ror:2 row_mask:0xf bank_mask:0xf
  s_nop 1
  v_add_f32_dpp v26, v26, v26 row_ror:1 row_mask:0xf bank_mask:0xf
  v_mov_b32 v25, v26
  s_nop 1
  v_permlane16_swap_b32 v26, v25
  v_add_f32 v26, v26, v25
  v_mov_b32 v25, v26
  s_nop 1
  v_permlane32_swap_b32 v26, v25
  v_add_f32 v26, v26, v25
  v_mul_f32 v26, 0.5, v26
  s_add_u32 s50, s50, 16384
  v_mov_b32 v28, s50
  s_waitcnt lgkmcnt(0)
  v_mov_b32 v25, v27
  ds_write_b32 v58, v59 offset:64
  s_mov_b64 exec, 1
  global_store_dwordx4 v28, v[24:27], s[42:43] sc1
  s_nop 1
  s_mov_b64 exec, -1
  s_waitcnt vmcnt(5)
  buffer_load_dwordx4 v[128:131], v1, s[12:15], s44 offen nt
  s_add_u32 s44, s44, 4096
  s_waitcnt vmcnt(5)
  buffer_load_dwordx4 v[132:135], v1, s[12:15], s44 offen nt
  s_add_u32 s44, s44, 4096
  s_waitcnt vmcnt(5)
  buffer_load_dwordx4 v[136:139], v1, s[12:15], s44 offen nt
  s_add_u32 s44, s44, 4096
  s_waitcnt vmcnt(5)
  buffer_load_dwordx4 v[140:143], v1, s[12:15], s44 offen nt
  s_add_u32 s44, s44, 4096
  s_waitcnt vmcnt(5)
  buffer_load_dwordx4 v[144:147], v1, s[12:15], s44 offen nt
  s_add_u32 s44, s44, 4096
  s_waitcnt vmcnt(5)
  buffer_load_dwordx4 v[148:151], v1, s[12:15], s44 offen nt
  s_add_u32 s44, s44, 4096
  s_waitcnt vmcnt(5)
  buffer_load_dwordx4 v[152:155], v1, s[12:15], s44 offen nt
  s_add_u32 s44, s44, 4096
  s_waitcnt vmcnt(5)
  buffer_load_dwordx4 v[156:159], v1, s[12:15], s44 offen nt
  s_add_u32 s44, s44, 4096
  s_waitcnt vmcnt(5)
  buffer_load_dwordx4 v[160:163], v1, s[12:15], s44 offen nt
  s_add_u32 s44, s44, 4096
  s_waitcnt vmcnt(5)
  buffer_load_dwordx4 v[164:167], v1, s[12:15], s44 offen nt
  s_add_u32 s44, s44, 4096
  s_waitcnt vmcnt(5)
  buffer_load_dwordx4 v[168:171], v1, s[12:15], s44 offen nt
  s_add_u32 s44, s44, 4096
  s_waitcnt vmcnt(5)
  buffer_load_dwordx4 v[172:175], v1, s[12:15], s44 offen nt
  s_add_u32 s44, s44, 4096
  s_waitcnt vmcnt(5)
  buffer_load_dwordx4 v[176:179], v1, s[12:15], s44 offen nt
  s_add_u32 s44, s44, 4096
  s_waitcnt vmcnt(5)
  buffer_load_dwordx4 v[180:183], v1, s[12:15], s44 offen nt
  s_add_u32 s44, s44, 4096
  s_waitcnt vmcnt(5)
  buffer_load_dwordx4 v[184:187], v1, s[12:15], s44 offen nt
  s_add_u32 s44, s44, 4096
  s_waitcnt vmcnt(5)
  buffer_load_dwordx4 v[188:191], v1, s[12:15], s44 offen nt
  s_add_u32 s44, s44, 4096
  s_waitcnt vmcnt(5)
  buffer_load_dwordx4 v[192:195], v1, s[12:15], s44 offen nt
  s_add_u32 s44, s44, 4096
  s_waitcnt vmcnt(5)
  buffer_load_dwordx4 v[196:199], v1, s[12:15], s44 offen nt
  s_add_u32 s44, s44, 4096
  s_waitcnt vmcnt(5)
  buffer_load_dwordx4 v[200:203], v1, s[12:15], s44 offen nt
  s_add_u32 s44, s44, 4096
  s_waitcnt vmcnt(5)
  buffer_load_dwordx4 v[204:207], v1, s[12:15], s44 offen nt
  s_add_u32 s44, s44, 4096
  s_waitcnt vmcnt(5)
  buffer_load_dwordx4 v[208:211], v1, s[12:15], s44 offen nt
  s_add_u32 s44, s44, 4096
  s_waitcnt vmcnt(5)
  buffer_load_dwordx4 v[212:215], v1, s[12:15], s44 offen nt
  s_add_u32 s44, s44, 4096
  s_waitcnt vmcnt(5)
  buffer_load_dwordx4 v[216:219], v1, s[12:15], s44 offen nt
  s_add_u32 s44, s44, 4096
  s_waitcnt vmcnt(5)
  buffer_load_dwordx4 v[220:223], v1, s[12:15], s44 offen nt
  s_add_u32 s44, s44, 4096
  s_waitcnt vmcnt(5)
  buffer_load_dwordx4 v[224:227], v1, s[12:15], s44 offen nt
  s_add_u32 s44, s44, 4096
  s_waitcnt vmcnt(5)
  buffer_load_dwordx4 v[228:231], v1, s[12:15], s44 offen nt
  s_add_u32 s44, s44, 4096
  s_waitcnt vmcnt(5)
  buffer_load_dwordx4 v[232:235], v1, s[12:15], s44 offen nt
  s_add_u32 s44, s44, 4096
  s_waitcnt vmcnt(5)
  buffer_load_dwordx4 v[236:239], v1, s[12:15], s44 offen nt
  s_add_u32 s44, s44, 4096
  s_waitcnt vmcnt(5)
  buffer_load_dwordx4 v[240:243], v1, s[12:15], s44 offen nt
  s_add_u32 s44, s44, 4096
  s_waitcnt vmcnt(5)
  buffer_load_dwordx4 v[244:247], v1, s[12:15], s44 offen nt
  s_add_u32 s44, s44, 4096
  s_waitcnt vmcnt(5)
  buffer_load_dwordx4 v[248:251], v1, s[12:15], s44 offen nt
  s_add_u32 s44, s44, 4096
  s_waitcnt vmcnt(5)
  buffer_load_dwordx4 v[252:255], v1, s[12:15], s44 offen nt
  s_add_u32 s44, s44, 4096
  s_waitcnt vmcnt(5)
  buffer_load_dwordx4 v[64:67], v1, s[12:15], s44 offen nt
  s_add_u32 s44, s44, 4096
  s_waitcnt vmcnt(5)
  buffer_load_dwordx4 v[68:71], v1, s[12:15], s44 offen nt
  s_add_u32 s44, s44, 4096
  s_waitcnt vmcnt(5)
  buffer_load_dwordx4 v[72:75], v1, s[12:15], s44 offen nt
  s_add_u32 s44, s44, 4096
  s_waitcnt vmcnt(5)
  buffer_load_dwordx4 v[76:79], v1, s[12:15], s44 offen nt
  s_add_u32 s44, s44, 4096
  s_waitcnt vmcnt(5)
  buffer_load_dwordx4 v[80:83], v1, s[12:15], s44 offen nt
  s_add_u32 s44, s44, 4096
  s_waitcnt vmcnt(5)
  buffer_load_dwordx4 v[84:87], v1, s[12:15], s44 offen nt
  s_add_u32 s44, s44, 4096
  s_waitcnt vmcnt(5)
  buffer_load_dwordx4 v[88:91], v1, s[12:15], s44 offen nt
  s_add_u32 s44, s44, 4096
  s_waitcnt vmcnt(5)
  buffer_load_dwordx4 v[92:95], v1, s[12:15], s44 offen nt
  s_add_u32 s44, s44, 4096
  v_mov_b32 v8, 0
  v_mov_b32 v9, 0
  v_mov_b32 v10, 0
  v_mov_b32 v11, 0
  v_mov_b32 v12, 0
  v_mov_b32 v13, 0
  v_mov_b32 v14, 0
  v_mov_b32 v15, 0
  v_mov_b32 v56, 12572
  v_mov_b32 v59, 7
  s_barrier
  ds_read_b128 v[32:35], v3 offset:640
  ds_read_b128 v[36:39], v3 offset:656
  ds_read_b128 v[40:43], v3 offset:0
  ds_read_b128 v[44:47], v3 offset:16
  s_waitcnt vmcnt(5) lgkmcnt(0)
  v_lshrrev_b32 v48, 16, v32
  v_dot2c_f32_bf16 v8, v48, v64
  v_dot2c_f32_bf16 v9, v32, v64
  v_dot2c_f32_bf16 v10, v48, v65
  v_dot2c_f32_bf16 v11, v32, v65
  v_dot2c_f32_bf16 v12, v48, v66
  v_dot2c_f32_bf16 v13, v32, v66
  v_dot2c_f32_bf16 v14, v48, v67
  v_dot2c_f32_bf16 v15, v32, v67
  buffer_load_dwordx4 v[64:67], v1, s[12:15], s44 offen nt
  s_add_u32 s44, s44, 4096
  s_waitcnt lgkmcnt(0)
  ds_read_b128 v[16:19], v3 offset:128
  ds_read_b128 v[20:23], v3 offset:144
  v_lshrrev_b32 v48, 16, v40
  v_dot2c_f32_bf16 v8, v48, v96
  v_dot2c_f32_bf16 v9, v40, v96
  v_dot2c_f32_bf16 v10, v48, v97
  v_dot2c_f32_bf16 v11, v40, v97
  v_dot2c_f32_bf16 v12, v48, v98
  v_dot2c_f32_bf16 v13, v40, v98
  v_dot2c_f32_bf16 v14, v48, v99
  v_dot2c_f32_bf16 v15, v40, v99
  v_lshrrev_b32 v48, 16, v41
  v_dot2c_f32_bf16 v8, v48, v100
  v_dot2c_f32_bf16 v9, v41, v100
  v_dot2c_f32_bf16 v10, v48, v101
  v_dot2c_f32_bf16 v11, v41, v101
  v_dot2c_f32_bf16 v12, v48, v102
  v_dot2c_f32_bf16 v13, v41, v102
  v_dot2c_f32_bf16 v14, v48, v103
  v_dot2c_f32_bf16 v15, v41, v103
  v_lshrrev_b32 v48, 16, v42
  v_dot2c_f32_bf16 v8, v48, v104
  v_dot2c_f32_bf16 v9, v42, v104
  v_dot2c_f32_bf16 v10, v48, v105
  v_dot2c_f32_bf16 v11, v42, v105
  v_dot2c_f32_bf16 v12, v48, v106
  v_dot2c_f32_bf16 v13, v42, v106
  v_dot2c_f32_bf16 v14, v48, v107
  v_dot2c_f32_bf16 v15, v42, v107
  v_lshrrev_b32 v48, 16, v43
  v_dot2c_f32_bf16 v8, v48, v108
  v_dot2c_f32_bf16 v9, v43, v108
  v_dot2c_f32_bf16 v10, v48, v109
  v_dot2c_f32_bf16 v11, v43, v109
  v_dot2c_f32_bf16 v12, v48, v110
  v_dot2c_f32_bf16 v13, v43, v110
  v_dot2c_f32_bf16 v14, v48, v111
  v_dot2c_f32_bf16 v15, v43, v111
  v_lshrrev_b32 v48, 16, v44
  v_dot2c_f32_bf16 v8, v48, v112
  v_dot2c_f32_bf16 v9, v44, v112
  v_dot2c_f32_bf16 v10, v48, v113
  v_dot2c_f32_bf16 v11, v44, v113
  v_dot2c_f32_bf16 v12, v48, v114
  v_dot2c_f32_bf16 v13, v44, v114
  v_dot2c_f32_bf16 v14, v48, v115
  v_dot2c_f32_bf16 v15, v44, v115
  s_waitcnt vmcnt(5)
  v_lshrrev_b32 v48, 16, v33
  v_dot2c_f32_bf16 v8, v48, v68
  v_dot2c_f32_bf16 v9, v33, v68
  v_dot2c_f32_bf16 v10, v48, v69
  v_dot2c_f32_bf16 v11, v33, v69
  v_dot2c_f32_bf16 v12, v48, v70
  v_dot2c_f32_bf16 v13, v33, v70
  v_dot2c_f32_bf16 v14, v48, v71
  v_dot2c_f32_bf16 v15, v33, v71
  buffer_load_dwordx4 v[68:71], v1, s[12:15], s44 offen nt
  s_add_u32 s44, s44, 4096
  v_lshrrev_b32 v48, 16, v45
  v_dot2c_f32_bf16 v8, v48, v116
  v_dot2c_f32_bf16 v9, v45, v116
  v_dot2c_f32_bf16 v10, v48, v117
  v_dot2c_f32_bf16 v11, v45, v117
  v_dot2c_f32_bf16 v12, v48, v118
  v_dot2c_f32_bf16 v13, v45, v118
  v_dot2c_f32_bf16 v14, v48, v119
  v_dot2c_f32_bf16 v15, v45, v119
  v_lshrrev_b32 v48, 16, v46
  v_dot2c_f32_bf16 v8, v48, v120
  v_dot2c_f32_bf16 v9, v46, v120
  v_dot2c_f32_bf16 v10, v48, v121
  v_dot2c_f32_bf16 v11, v46, v121
  v_dot2c_f32_bf16 v12, v48, v122
  v_dot2c_f32_bf16 v13, v46, v122
  v_dot2c_f32_bf16 v14, v48, v123
  v_dot2c_f32_bf16 v15, v46, v123
  v_lshrrev_b32 v48, 16, v47
  v_dot2c_f32_bf16 v8, v48, v124
  v_dot2c_f32_bf16 v9, v47, v124
  v_dot2c_f32_bf16 v10, v48, v125
  v_dot2c_f32_bf16 v11, v47, v125
  v_dot2c_f32_bf16 v12, v48, v126
  v_dot2c_f32_bf16 v13, v47, v126
  v_dot2c_f32_bf16 v14, v48, v127
  v_dot2c_f32_bf16 v15, v47, v127
  s_waitcnt lgkmcnt(0)
  ds_read_b128 v[40:43], v3 offset:256
  ds_read_b128 v[44:47], v3 offset:272
  v_lshrrev_b32 v48, 16, v16
  v_dot2c_f32_bf16 v8, v48, v128
  v_dot2c_f32_bf16 v9, v16, v128
  v_dot2c_f32_bf16 v10, v48, v129
  v_dot2c_f32_bf16 v11, v16, v129
  v_dot2c_f32_bf16 v12, v48, v130
  v_dot2c_f32_bf16 v13, v16, v130
  v_dot2c_f32_bf16 v14, v48, v131
  v_dot2c_f32_bf16 v15, v16, v131
  v_lshrrev_b32 v48, 16, v17
  v_dot2c_f32_bf16 v8, v48, v132
  v_dot2c_f32_bf16 v9, v17, v132
  v_dot2c_f32_bf16 v10, v48, v133
  v_dot2c_f32_bf16 v11, v17, v133
  v_dot2c_f32_bf16 v12, v48, v134
  v_dot2c_f32_bf16 v13, v17, v134
  v_dot2c_f32_bf16 v14, v48, v135
  v_dot2c_f32_bf16 v15, v17, v135
  s_waitcnt vmcnt(5)
  v_lshrrev_b32 v48, 16, v34
  v_dot2c_f32_bf16 v8, v48, v72
  v_dot2c_f32_bf16 v9, v34, v72
  v_dot2c_f32_bf16 v10, v48, v73
  v_dot2c_f32_bf16 v11, v34, v73
  v_dot2c_f32_bf16 v12, v48, v74
  v_dot2c_f32_bf16 v13, v34, v74
  v_dot2c_f32_bf16 v14, v48, v75
  v_dot2c_f32_bf16 v15, v34, v75
  buffer_load_dwordx4 v[72:75], v1, s[12:15], s44 offen nt
  s_add_u32 s44, s44, 4096
  v_lshrrev_b32 v48, 16, v18
  v_dot2c_f32_bf16 v8, v48, v136
  v_dot2c_f32_bf16 v9, v18, v136
  v_dot2c_f32_bf16 v10, v48, v137
  v_dot2c_f32_bf16 v11, v18, v137
  v_dot2c_f32_bf16 v12, v48, v138
  v_dot2c_f32_bf16 v13, v18, v138
  v_dot2c_f32_bf16 v14, v48, v139
  v_dot2c_f32_bf16 v15, v18, v139
  v_lshrrev_b32 v48, 16, v19
  v_dot2c_f32_bf16 v8, v48, v140
  v_dot2c_f32_bf16 v9, v19, v140
  v_dot2c_f32_bf16 v10, v48, v141
  v_dot2c_f32_bf16 v11, v19, v141
  v_dot2c_f32_bf16 v12, v48, v142
  v_dot2c_f32_bf16 v13, v19, v142
  v_dot2c_f32_bf16 v14, v48, v143
  v_dot2c_f32_bf16 v15, v19, v143
  v_lshrrev_b32 v48, 16, v20
  v_dot2c_f32_bf16 v8, v48, v144
  v_dot2c_f32_bf16 v9, v20, v144
  v_dot2c_f32_bf16 v10, v48, v145
  v_dot2c_f32_bf16 v11, v20, v145
  v_dot2c_f32_bf16 v12, v48, v146
  v_dot2c_f32_bf16 v13, v20, v146
  v_dot2c_f32_bf16 v14, v48, v147
  v_dot2c_f32_bf16 v15, v20, v147
  v_lshrrev_b32 v48, 16, v21
  v_dot2c_f32_bf16 v8, v48, v148
  v_dot2c_f32_bf16 v9, v21, v148
  v_dot2c_f32_bf16 v10, v48, v149
  v_dot2c_f32_bf16 v11, v21, v149
  v_dot2c_f32_bf16 v12, v48, v150
  v_dot2c_f32_bf16 v13, v21, v150
  v_dot2c_f32_bf16 v14, v48, v151
  v_dot2c_f32_bf16 v15, v21, v151
  v_lshrrev_b32 v48, 16, v22
  v_dot2c_f32_bf16 v8, v48, v152
  v_dot2c_f32_bf16 v9, v22, v152
  v_dot2c_f32_bf16 v10, v48, v153
  v_dot2c_f32_bf16 v11, v22, v153
  v_dot2c_f32_bf16 v12, v48, v154
  v_dot2c_f32_bf16 v13, v22, v154
  v_dot2c_f32_bf16 v14, v48, v155
  v_dot2c_f32_bf16 v15, v22, v155
  s_waitcnt vmcnt(5)
  v_lshrrev_b32 v48, 16, v35
  v_dot2c_f32_bf16 v8, v48, v76
  v_dot2c_f32_bf16 v9, v35, v76
  v_dot2c_f32_bf16 v10, v48, v77
  v_dot2c_f32_bf16 v11, v35, v77
  v_dot2c_f32_bf16 v12, v48, v78
  v_dot2c_f32_bf16 v13, v35, v78
  v_dot2c_f32_bf16 v14, v48, v79
  v_dot2c_f32_bf16 v15, v35, v79
  buffer_load_dwordx4 v[76:79], v1, s[12:15], s44 offen nt
  s_add_u32 s44, s44, 4096
  v_lshrrev_b32 v48, 16, v23
  v_dot2c_f32_bf16 v8, v48, v156
  v_dot2c_f32_bf16 v9, v23, v156
  v_dot2c_f32_bf16 v10, v48, v157
  v_dot2c_f32_bf16 v11, v23, v157
  v_dot2c_f32_bf16 v12, v48, v158
  v_dot2c_f32_bf16 v13, v23, v158
  v_dot2c_f32_bf16 v14, v48, v159
  v_dot2c_f32_bf16 v15, v23, v159
  s_waitcnt lgkmcnt(0)
  ds_read_b128 v[16:19], v3 offset:384
  ds_read_b128 v[20:23], v3 offset:400
  v_lshrrev_b32 v48, 16, v40
  v_dot2c_f32_bf16 v8, v48, v160
  v_dot2c_f32_bf16 v9, v40, v160
  v_dot2c_f32_bf16 v10, v48, v161
  v_dot2c_f32_bf16 v11, v40, v161
  v_dot2c_f32_bf16 v12, v48, v162
  v_dot2c_f32_bf16 v13, v40, v162
  v_dot2c_f32_bf16 v14, v48, v163
  v_dot2c_f32_bf16 v15, v40, v163
  v_lshrrev_b32 v48, 16, v41
  v_dot2c_f32_bf16 v8, v48, v164
  v_dot2c_f32_bf16 v9, v41, v164
  v_dot2c_f32_bf16 v10, v48, v165
  v_dot2c_f32_bf16 v11, v41, v165
  v_dot2c_f32_bf16 v12, v48, v166
  v_dot2c_f32_bf16 v13, v41, v166
  v_dot2c_f32_bf16 v14, v48, v167
  v_dot2c_f32_bf16 v15, v41, v167
  v_lshrrev_b32 v48, 16, v42
  v_dot2c_f32_bf16 v8, v48, v168
  v_dot2c_f32_bf16 v9, v42, v168
  v_dot2c_f32_bf16 v10, v48, v169
  v_dot2c_f32_bf16 v11, v42, v169
  v_dot2c_f32_bf16 v12, v48, v170
  v_dot2c_f32_bf16 v13, v42, v170
  v_dot2c_f32_bf16 v14, v48, v171
  v_dot2c_f32_bf16 v15, v42, v171
  v_lshrrev_b32 v48, 16, v43
  v_dot2c_f32_bf16 v8, v48, v172
  v_dot2c_f32_bf16 v9, v43, v172
  v_dot2c_f32_bf16 v10, v48, v173
  v_dot2c_f32_bf16 v11, v43, v173
  v_dot2c_f32_bf16 v12, v48, v174
  v_dot2c_f32_bf16 v13, v43, v174
  v_dot2c_f32_bf16 v14, v48, v175
  v_dot2c_f32_bf16 v15, v43, v175
  s_waitcnt vmcnt(5)
  v_lshrrev_b32 v48, 16, v36
  v_dot2c_f32_bf16 v8, v48, v80
  v_dot2c_f32_bf16 v9, v36, v80
  v_dot2c_f32_bf16 v10, v48, v81
  v_dot2c_f32_bf16 v11, v36, v81
  v_dot2c_f32_bf16 v12, v48, v82
  v_dot2c_f32_bf16 v13, v36, v82
  v_dot2c_f32_bf16 v14, v48, v83
  v_dot2c_f32_bf16 v15, v36, v83
  buffer_load_dwordx4 v[80:83], v1, s[12:15], s44 offen nt
  s_add_u32 s44, s44, 4096
  v_lshrrev_b32 v48, 16, v44
  v_dot2c_f32_bf16 v8, v48, v176
  v_dot2c_f32_bf16 v9, v44, v176
  v_dot2c_f32_bf16 v10, v48, v177
  v_dot2c_f32_bf16 v11, v44, v177
  v_dot2c_f32_bf16 v12, v48, v178
  v_dot2c_f32_bf16 v13, v44, v178
  v_dot2c_f32_bf16 v14, v48, v179
  v_dot2c_f32_bf16 v15, v44, v179
  v_lshrrev_b32 v48, 16, v45
  v_dot2c_f32_bf16 v8, v48, v180
  v_dot2c_f32_bf16 v9, v45, v180
  v_dot2c_f32_bf16 v10, v48, v181
  v_dot2c_f32_bf16 v11, v45, v181
  v_dot2c_f32_bf16 v12, v48, v182
  v_dot2c_f32_bf16 v13, v45, v182
  v_dot2c_f32_bf16 v14, v48, v183
  v_dot2c_f32_bf16 v15, v45, v183
  v_lshrrev_b32 v48, 16, v46
  v_dot2c_f32_bf16 v8, v48, v184
  v_dot2c_f32_bf16 v9, v46, v184
  v_dot2c_f32_bf16 v10, v48, v185
  v_dot2c_f32_bf16 v11, v46, v185
  v_dot2c_f32_bf16 v12, v48, v186
  v_dot2c_f32_bf16 v13, v46, v186
  v_dot2c_f32_bf16 v14, v48, v187
  v_dot2c_f32_bf16 v15, v46, v187
  v_lshrrev_b32 v48, 16, v47
  v_dot2c_f32_bf16 v8, v48, v188
  v_dot2c_f32_bf16 v9, v47, v188
  v_dot2c_f32_bf16 v10, v48, v189
  v_dot2c_f32_bf16 v11, v47, v189
  v_dot2c_f32_bf16 v12, v48, v190
  v_dot2c_f32_bf16 v13, v47, v190
  v_dot2c_f32_bf16 v14, v48, v191
  v_dot2c_f32_bf16 v15, v47, v191
  s_waitcnt lgkmcnt(0)
  ds_read_b128 v[40:43], v3 offset:512
  ds_read_b128 v[44:47], v3 offset:528
  v_lshrrev_b32 v48, 16, v16
  v_dot2c_f32_bf16 v8, v48, v192
  v_dot2c_f32_bf16 v9, v16, v192
  v_dot2c_f32_bf16 v10, v48, v193
  v_dot2c_f32_bf16 v11, v16, v193
  v_dot2c_f32_bf16 v12, v48, v194
  v_dot2c_f32_bf16 v13, v16, v194
  v_dot2c_f32_bf16 v14, v48, v195
  v_dot2c_f32_bf16 v15, v16, v195
  s_waitcnt vmcnt(5)
  v_lshrrev_b32 v48, 16, v37
  v_dot2c_f32_bf16 v8, v48, v84
  v_dot2c_f32_bf16 v9, v37, v84
  v_dot2c_f32_bf16 v10, v48, v85
  v_dot2c_f32_bf16 v11, v37, v85
  v_dot2c_f32_bf16 v12, v48, v86
  v_dot2c_f32_bf16 v13, v37, v86
  v_dot2c_f32_bf16 v14, v48, v87
  v_dot2c_f32_bf16 v15, v37, v87
  buffer_load_dwordx4 v[84:87], v1, s[12:15], s44 offen nt
  s_add_u32 s44, s44, 4096
  v_lshrrev_b32 v48, 16, v17
  v_dot2c_f32_bf16 v8, v48, v196
  v_dot2c_f32_bf16 v9, v17, v196
  v_dot2c_f32_bf16 v10, v48, v197
  v_dot2c_f32_bf16 v11, v17, v197
  v_dot2c_f32_bf16 v12, v48, v198
  v_dot2c_f32_bf16 v13, v17, v198
  v_dot2c_f32_bf16 v14, v48, v199
  v_dot2c_f32_bf16 v15, v17, v199
  v_lshrrev_b32 v48, 16, v18
  v_dot2c_f32_bf16 v8, v48, v200
  v_dot2c_f32_bf16 v9, v18, v200
  v_dot2c_f32_bf16 v10, v48, v201
  v_dot2c_f32_bf16 v11, v18, v201
  v_dot2c_f32_bf16 v12, v48, v202
  v_dot2c_f32_bf16 v13, v18, v202
  v_dot2c_f32_bf16 v14, v48, v203
  v_dot2c_f32_bf16 v15, v18, v203
  v_lshrrev_b32 v48, 16, v19
  v_dot2c_f32_bf16 v8, v48, v204
  v_dot2c_f32_bf16 v9, v19, v204
  v_dot2c_f32_bf16 v10, v48, v205
  v_dot2c_f32_bf16 v11, v19, v205
  v_dot2c_f32_bf16 v12, v48, v206
  v_dot2c_f32_bf16 v13, v19, v206
  v_dot2c_f32_bf16 v14, v48, v207
  v_dot2c_f32_bf16 v15, v19, v207
  v_lshrrev_b32 v48, 16, v20
  v_dot2c_f32_bf16 v8, v48, v208
  v_dot2c_f32_bf16 v9, v20, v208
  v_dot2c_f32_bf16 v10, v48, v209
  v_dot2c_f32_bf16 v11, v20, v209
  v_dot2c_f32_bf16 v12, v48, v210
  v_dot2c_f32_bf16 v13, v20, v210
  v_dot2c_f32_bf16 v14, v48, v211
  v_dot2c_f32_bf16 v15, v20, v211
  v_lshrrev_b32 v48, 16, v21
  v_dot2c_f32_bf16 v8, v48, v212
  v_dot2c_f32_bf16 v9, v21, v212
  v_dot2c_f32_bf16 v10, v48, v213
  v_dot2c_f32_bf16 v11, v21, v213
  v_dot2c_f32_bf16 v12, v48, v214
  v_dot2c_f32_bf16 v13, v21, v214
  v_dot2c_f32_bf16 v14, v48, v215
  v_dot2c_f32_bf16 v15, v21, v215
  s_waitcnt vmcnt(5)
  v_lshrrev_b32 v48, 16, v38
  v_dot2c_f32_bf16 v8, v48, v88
  v_dot2c_f32_bf16 v9, v38, v88
  v_dot2c_f32_bf16 v10, v48, v89
  v_dot2c_f32_bf16 v11, v38, v89
  v_dot2c_f32_bf16 v12, v48, v90
  v_dot2c_f32_bf16 v13, v38, v90
  v_dot2c_f32_bf16 v14, v48, v91
  v_dot2c_f32_bf16 v15, v38, v91
  buffer_load_dwordx4 v[88:91], v1, s[12:15], s44 offen nt
  s_add_u32 s44, s44, 4096
  v_lshrrev_b32 v48, 16, v22
  v_dot2c_f32_bf16 v8, v48, v216
  v_dot2c_f32_bf16 v9, v22, v216
  v_dot2c_f32_bf16 v10, v48, v217
  v_dot2c_f32_bf16 v11, v22, v217
  v_dot2c_f32_bf16 v12, v48, v218
  v_dot2c_f32_bf16 v13, v22, v218
  v_dot2c_f32_bf16 v14, v48, v219
  v_dot2c_f32_bf16 v15, v22, v219
  v_lshrrev_b32 v48, 16, v23
  v_dot2c_f32_bf16 v8, v48, v220
  v_dot2c_f32_bf16 v9, v23, v220
  v_dot2c_f32_bf16 v10, v48, v221
  v_dot2c_f32_bf16 v11, v23, v221
  v_dot2c_f32_bf16 v12, v48, v222
  v_dot2c_f32_bf16 v13, v23, v222
  v_dot2c_f32_bf16 v14, v48, v223
  v_dot2c_f32_bf16 v15, v23, v223
  s_waitcnt lgkmcnt(0)
  v_lshrrev_b32 v48, 16, v40
  v_dot2c_f32_bf16 v8, v48, v224
  v_dot2c_f32_bf16 v9, v40, v224
  v_dot2c_f32_bf16 v10, v48, v225
  v_dot2c_f32_bf16 v11, v40, v225
  v_dot2c_f32_bf16 v12, v48, v226
  v_dot2c_f32_bf16 v13, v40, v226
  v_dot2c_f32_bf16 v14, v48, v227
  v_dot2c_f32_bf16 v15, v40, v227
  v_lshrrev_b32 v48, 16, v41
  v_dot2c_f32_bf16 v8, v48, v228
  v_dot2c_f32_bf16 v9, v41, v228
  v_dot2c_f32_bf16 v10, v48, v229
  v_dot2c_f32_bf16 v11, v41, v229
  v_dot2c_f32_bf16 v12, v48, v230
  v_dot2c_f32_bf16 v13, v41, v230
  v_dot2c_f32_bf16 v14, v48, v231
  v_dot2c_f32_bf16 v15, v41, v231
  v_lshrrev_b32 v48, 16, v42
  v_dot2c_f32_bf16 v8, v48, v232
  v_dot2c_f32_bf16 v9, v42, v232
  v_dot2c_f32_bf16 v10, v48, v233
  v_dot2c_f32_bf16 v11, v42, v233
  v_dot2c_f32_bf16 v12, v48, v234
  v_dot2c_f32_bf16 v13, v42, v234
  v_dot2c_f32_bf16 v14, v48, v235
  v_dot2c_f32_bf16 v15, v42, v235
  s_waitcnt vmcnt(5)
  v_lshrrev_b32 v48, 16, v39
  v_dot2c_f32_bf16 v8, v48, v92
  v_dot2c_f32_bf16 v9, v39, v92
  v_dot2c_f32_bf16 v10, v48, v93
  v_dot2c_f32_bf16 v11, v39, v93
  v_dot2c_f32_bf16 v12, v48, v94
  v_dot2c_f32_bf16 v13, v39, v94
  v_dot2c_f32_bf16 v14, v48, v95
  v_dot2c_f32_bf16 v15, v39, v95
  buffer_load_dwordx4 v[92:95], v1, s[12:15], s44 offen nt
  s_add_u32 s44, s44, 4096
  v_lshrrev_b32 v48, 16, v43
  v_dot2c_f32_bf16 v8, v48, v236
  v_dot2c_f32_bf16 v9, v43, v236
  v_dot2c_f32_bf16 v10, v48, v237
  v_dot2c_f32_bf16 v11, v43, v237
  v_dot2c_f32_bf16 v12, v48, v238
  v_dot2c_f32_bf16 v13, v43, v238
  v_dot2c_f32_bf16 v14, v48, v239
  v_dot2c_f32_bf16 v15, v43, v239
  v_lshrrev_b32 v48, 16, v44
  v_dot2c_f32_bf16 v8, v48, v240
  v_dot2c_f32_bf16 v9, v44, v240
  v_dot2c_f32_bf16 v10, v48, v241
  v_dot2c_f32_bf16 v11, v44, v241
  v_dot2c_f32_bf16 v12, v48, v242
  v_dot2c_f32_bf16 v13, v44, v242
  v_dot2c_f32_bf16 v14, v48, v243
  v_dot2c_f32_bf16 v15, v44, v243
  v_lshrrev_b32 v48, 16, v45
  v_dot2c_f32_bf16 v8, v48, v244
  v_dot2c_f32_bf16 v9, v45, v244
  v_dot2c_f32_bf16 v10, v48, v245
  v_dot2c_f32_bf16 v11, v45, v245
  v_dot2c_f32_bf16 v12, v48, v246
  v_dot2c_f32_bf16 v13, v45, v246
  v_dot2c_f32_bf16 v14, v48, v247
  v_dot2c_f32_bf16 v15, v45, v247
  v_lshrrev_b32 v48, 16, v46
  v_dot2c_f32_bf16 v8, v48, v248
  v_dot2c_f32_bf16 v9, v46, v248
  v_dot2c_f32_bf16 v10, v48, v249
  v_dot2c_f32_bf16 v11, v46, v249
  v_dot2c_f32_bf16 v12, v48, v250
  v_dot2c_f32_bf16 v13, v46, v250
  v_dot2c_f32_bf16 v14, v48, v251
  v_dot2c_f32_bf16 v15, v46, v251
  v_lshrrev_b32 v48, 16, v47
  v_dot2c_f32_bf16 v8, v48, v252
  v_dot2c_f32_bf16 v9, v47, v252
  v_dot2c_f32_bf16 v10, v48, v253
  v_dot2c_f32_bf16 v11, v47, v253
  v_dot2c_f32_bf16 v12, v48, v254
  v_dot2c_f32_bf16 v13, v47, v254
  v_dot2c_f32_bf16 v14, v48, v255
  v_dot2c_f32_bf16 v15, v47, v255
  v_add_u32 v3, 768, v3
  ds_read_b32 v57, v56
  ds_read_b128 v[32:35], v3 offset:0
  ds_read_b128 v[36:39], v3 offset:16
  s_mov_b32 s71, 7
L_v_top:
  s_waitcnt lgkmcnt(0)
  v_readfirstlane_b32 s50, v57
  s_nop 0
  s_cmp_ge_u32 s50, 0xfffffffe
  s_cbranch_scc1 L_v_slow
  s_add_u32 s44, s50, s53
  v_add_u32 v56, 4, v56
  ds_write_b32 v58, v59 offset:112
  v_add_u32 v59, 1, v59
  s_add_u32 s71, s71, 1
  s_cmp_gt_u32 s71, 58
  s_cbranch_scc1 L_w_body
  s_waitcnt vmcnt(5)
  v_lshrrev_b32 v48, 16, v32
  v_dot2c_f32_bf16 v8, v48, v64
  v_dot2c_f32_bf16 v9, v32, v64
  v_dot2c_f32_bf16 v10, v48, v65
  v_dot2c_f32_bf16 v11, v32, v65
  v_dot2c_f32_bf16 v12, v48, v66
  v_dot2c_f32_bf16 v13, v32, v66
  v_dot2c_f32_bf16 v14, v48, v67
  v_dot2c_f32_bf16 v15, v32, v67
  buffer_load_dwordx4 v[64:67], v1, s[12:15], s44 offen nt
  s_add_u32 s44, s44, 4096
  s_waitcnt vmcnt(5)
  v_lshrrev_b32 v48, 16, v33
  v_dot2c_f32_bf16 v8, v48, v68
  v_dot2c_f32_bf16 v9, v33, v68
  v_dot2c_f32_bf16 v10, v48, v69
  v_dot2c_f32_bf16 v11, v33, v69
  v_dot2c_f32_bf16 v12, v48, v70
  v_dot2c_f32_bf16 v13, v33, v70
  v_dot2c_f32_bf16 v14, v48, v71
  v_dot2c_f32_bf16 v15, v33, v71
  buffer_load_dwordx4 v[68:71], v1, s[12:15], s44 offen nt
  s_add_u32 s44, s44, 4096
  s_waitcnt vmcnt(5)
  v_lshrrev_b32 v48, 16, v34
  v_dot2c_f32_bf16 v8, v48, v72
  v_dot2c_f32_bf16 v9, v34, v72
  v_dot2c_f32_bf16 v10, v48, v73
  v_dot2c_f32_bf16 v11, v34, v73
  v_dot2c_f32_bf16 v12, v48, v74
  v_dot2c_f32_bf16 v13, v34, v74
  v_dot2c_f32_bf16 v14, v48, v75
  v_dot2c_f32_bf16 v15, v34, v75
  buffer_load_dwordx4 v[72:75], v1, s[12:15], s44 offen nt
  s_add_u32 s44, s44, 4096
  s_waitcnt vmcnt(5)
  v_lshrrev_b32 v48, 16, v35
  v_dot2c_f32_bf16 v8, v48, v76
  v_dot2c_f32_bf16 v9, v35, v76
  v_dot2c_f32_bf16 v10, v48, v77
  v_dot2c_f32_bf16 v11, v35, v77
  v_dot2c_f32_bf16 v12, v48, v78
  v_dot2c_f32_bf16 v13, v35, v78
  v_dot2c_f32_bf16 v14, v48, v79
  v_dot2c_f32_bf16 v15, v35, v79
  buffer_load_dwordx4 v[76:79], v1, s[12:15], s44 offen nt
  s_add_u32 s44, s44, 4096
  s_waitcnt vmcnt(5)
  v_lshrrev_b32 v48, 16, v36
  v_dot2c_f32_bf16 v8, v48, v80
  v_dot2c_f32_bf16 v9, v36, v80
  v_dot2c_f32_bf16 v10, v48, v81
  v_dot2c_f32_bf16 v11, v36, v81
  v_dot2c_f32_bf16 v12, v48, v82
  v_dot2c_f32_bf16 v13, v36, v82
  v_dot2c_f32_bf16 v14, v48, v83
  v_dot2c_f32_bf16 v15, v36, v83
  buffer_load_dwordx4 v[80:83], v1, s[12:15], s44 offen nt
  s_add_u32 s44, s44, 4096
  s_waitcnt vmcnt(5)
  v_lshrrev_b32 v48, 16, v37
  v_dot2c_f32_bf16 v8, v48, v84
  v_dot2c_f32_bf16 v9, v37, v84
  v_dot2c_f32_bf16 v10, v48, v85
  v_dot2c_f32_bf16 v11, v37, v85
  v_dot2c_f32_bf16 v12, v48, v86
  v_dot2c_f32_bf16 v13, v37, v86
  v_dot2c_f32_bf16 v14, v48, v87
  v_dot2c_f32_bf16 v15, v37, v87
  buffer_load_dwordx4 v[84:87], v1, s[12:15], s44 offen nt
  s_add_u32 s44, s44, 4096
  s_waitcnt vmcnt(5)
  v_lshrrev_b32 v48, 16, v38
  v_dot2c_f32_bf16 v8, v48, v88
  v_dot2c_f32_bf16 v9, v38, v88
  v_dot2c_f32_bf16 v10, v48, v89
  v_dot2c_f32_bf16 v11, v38, v89
  v_dot2c_f32_bf16 v12, v48, v90
  v_dot2c_f32_bf16 v13, v38, v90
  v_dot2c_f32_bf16 v14, v48, v91
  v_dot2c_f32_bf16 v15, v38, v91
  buffer_load_dwordx4 v[88:91], v1, s[12:15], s44 offen nt
  s_add_u32 s44, s44, 4096
  ds_read_b32 v57, v56
  s_waitcnt vmcnt(5)
  v_lshrrev_b32 v48, 16, v39
  v_dot2c_f32_bf16 v8, v48, v92
  v_dot2c_f32_bf16 v9, v39, v92
  v_dot2c_f32_bf16 v10, v48, v93
  v_dot2c_f32_bf16 v11, v39, v93
  v_dot2c_f32_bf16 v12, v48, v94
  v_dot2c_f32_bf16 v13, v39, v94
  v_dot2c_f32_bf16 v14, v48, v95
  v_dot2c_f32_bf16 v15, v39, v95
  buffer_load_dwordx4 v[92:95], v1, s[12:15], s44 offen nt
  s_add_u32 s44, s44, 4096
  v_add_u32 v3, 128, v3
  ds_read_b128 v[32:35], v3 offset:0
  ds_read_b128 v[36:39], v3 offset:16
  s_branch L_v_top
L_w_top:
  s_waitcnt lgkmcnt(0)
  v_readfirstlane_b32 s50, v57
  s_nop 0
  s_cmp_ge_u32 s50, 0xfffffffe
  s_cbranch_scc1 L_w_slow
  s_add_u32 s44, s50, s53
  v_add_u32 v56, 4, v56
  ds_write_b32 v58, v59 offset:112
  v_add_u32 v59, 1, v59
L_w_body:
  s_waitcnt vmcnt(7)
  v_lshrrev_b32 v48, 16, v32
  v_dot2c_f32_bf16 v8, v48, v64
  v_dot2c_f32_bf16 v9, v32, v64
  v_dot2c_f32_bf16 v10, v48, v65
  v_dot2c_f32_bf16 v11, v32, v65
  v_dot2c_f32_bf16 v12, v48, v66
  v_dot2c_f32_bf16 v13, v32, v66
  v_dot2c_f32_bf16 v14, v48, v67
  v_dot2c_f32_bf16 v15, v32, v67
  buffer_load_dwordx4 v[64:67], v1, s[12:15], s44 offen nt
  s_add_u32 s44, s44, 4096
  s_waitcnt vmcnt(7)
  v_lshrrev_b32 v48, 16, v33
  v_dot2c_f32_bf16 v8, v48, v68
  v_dot2c_f32_bf16 v9, v33, v68
  v_dot2c_f32_bf16 v10, v48, v69
  v_dot2c_f32_bf16 v11, v33, v69
  v_dot2c_f32_bf16 v12, v48, v70
  v_dot2c_f32_bf16 v13, v33, v70
  v_dot2c_f32_bf16 v14, v48, v71
  v_dot2c_f32_bf16 v15, v33, v71
  buffer_load_dwordx4 v[68:71], v1, s[12:15], s44 offen nt
  s_add_u32 s44, s44, 4096
  s_waitcnt vmcnt(7)
  v_lshrrev_b32 v48, 16, v34
  v_dot2c_f32_bf16 v8, v48, v72
  v_dot2c_f32_bf16 v9, v34, v72
  v_dot2c_f32_bf16 v10, v48, v73
  v_dot2c_f32_bf16 v11, v34, v73
  v_dot2c_f32_bf16 v12, v48, v74
  v_dot2c_f32_bf16 v13, v34, v74
  v_dot2c_f32_bf16 v14, v48, v75
  v_dot2c_f32_bf16 v15, v34, v75
  buffer_load_dwordx4 v[72:75], v1, s[12:15], s44 offen nt
  s_add_u32 s44, s44, 4096
  s_waitcnt vmcnt(7)
  v_lshrrev_b32 v48, 16, v35
  v_dot2c_f32_bf16 v8, v48, v76
  v_dot2c_f32_bf16 v9, v35, v76
  v_dot2c_f32_bf16 v10, v48, v77
  v_dot2c_f32_bf16 v11, v35, v77
  v_dot2c_f32_bf16 v12, v48, v78
  v_dot2c_f32_bf16 v13, v35, v78
  v_dot2c_f32_bf16 v14, v48, v79
  v_dot2c_f32_bf16 v15, v35, v79
  buffer_load_dwordx4 v[76:79], v1, s[12:15], s44 offen nt
  s_add_u32 s44, s44, 4096
  s_waitcnt vmcnt(7)
  v_lshrrev_b32 v48, 16, v36
  v_dot2c_f32_bf16 v8, v48, v80
  v_dot2c_f32_bf16 v9, v36, v80
  v_dot2c_f32_bf16 v10, v48, v81
  v_dot2c_f32_bf16 v11, v36, v81
  v_dot2c_f32_bf16 v12, v48, v82
  v_dot2c_f32_bf16 v13, v36, v82
  v_dot2c_f32_bf16 v14, v48, v83
  v_dot2c_f32_bf16 v15, v36, v83
  buffer_load_dwordx4 v[80:83], v1, s[12:15], s44 offen nt
  s_add_u32 s44, s44, 4096
  s_waitcnt vmcnt(7)
  v_lshrrev_b32 v48, 16, v37
  v_dot2c_f32_bf16 v8, v48, v84
  v_dot2c_f32_bf16 v9, v37, v84
  v_dot2c_f32_bf16 v10, v48, v85
  v_dot2c_f32_bf16 v11, v37, v85
  v_dot2c_f32_bf16 v12, v48, v86
  v_dot2c_f32_bf16 v13, v37, v86
  v_dot2c_f32_bf16 v14, v48, v87
  v_dot2c_f32_bf16 v15, v37, v87
  buffer_load_dwordx4 v[84:87], v1, s[12:15], s44 offen nt
  s_add_u32 s44, s44, 4096
  s_waitcnt vmcnt(7)
  v_lshrrev_b32 v48, 16, v38
  v_dot2c_f32_bf16 v8, v48, v88
  v_dot2c_f32_bf16 v9, v38, v88
  v_dot2c_f32_bf16 v10, v48, v89
  v_dot2c_f32_bf16 v11, v38, v89
  v_dot2c_f32_bf16 v12, v48, v90
  v_dot2c_f32_bf16 v13, v38, v90
  v_dot2c_f32_bf16 v14, v48, v91
  v_dot2c_f32_bf16 v15, v38, v91
  buffer_load_dwordx4 v[88:91], v1, s[12:15], s44 offen nt
  s_add_u32 s44, s44, 4096
  ds_read_b32 v57, v56
  s_waitcnt vmcnt(7)
  v_lshrrev_b32 v48, 16, v39
  v_dot2c_f32_bf16 v8, v48, v92
  v_dot2c_f32_bf16 v9, v39, v92
  v_dot2c_f32_bf16 v10, v48, v93
  v_dot2c_f32_bf16 v11, v39, v93
  v_dot2c_f32_bf16 v12, v48, v94
  v_dot2c_f32_bf16 v13, v39, v94
  v_dot2c_f32_bf16 v14, v48, v95
  v_dot2c_f32_bf16 v15, v39, v95
  buffer_load_dwordx4 v[92:95], v1, s[12:15], s44 offen nt
  s_add_u32 s44, s44, 4096
  v_add_u32 v3, 128, v3
  ds_read_b128 v[32:35], v3 offset:0
  ds_read_b128 v[36:39], v3 offset:16
  s_branch L_w_top
L_w_slow:
  s_cmp_eq_u32 s50, 0xfffffffe
  s_cbranch_scc1 L_v_last
  s_sub_u32 s70, s70, 1
  s_cmp_eq_u32 s70, 0
  s_cbranch_scc1 L_v_last
  s_sleep 1
  ds_read_b32 v57, v56
  s_branch L_w_top
L_v_slow:
  s_cmp_eq_u32 s50, 0xfffffffe
  s_cbranch_scc1 L_v_last
  s_sub_u32 s70, s70, 1
  s_cmp_eq_u32 s70, 0
  s_cbranch_scc1 L_v_last
  s_sleep 1
  ds_read_b32 v57, v56
  s_branch L_v_top
L_v_last:
  v_lshrrev_b32 v51, 4, v0
  v_lshl_add_u32 v50, v51, 3, v50
  s_lshl_b32 s46, s6, 9
  v_add_u32 v50, s46, v50
  s_lshl_b32 s46, s2, 9
  s_add_u32 s46, s46, 65536
  v_add_u32 v51, s46, v1
  s_waitcnt vmcnt(7)
  v_lshrrev_b32 v48, 16, v32
  v_dot2c_f32_bf16 v8, v48, v64
  v_dot2c_f32_bf16 v9, v32, v64
  v_dot2c_f32_bf16 v10, v48, v65
  v_dot2c_f32_bf16 v11, v32, v65
  v_dot2c_f32_bf16 v12, v48, v66
  v_dot2c_f32_bf16 v13, v32, v66
  v_dot2c_f32_bf16 v14, v48, v67
  v_dot2c_f32_bf16 v15, v32, v67
  s_waitcnt vmcnt(6)
  v_lshrrev_b32 v48, 16, v33
  v_dot2c_f32_bf16 v8, v48, v68
  v_dot2c_f32_bf16 v9, v33, v68
  v_dot2c_f32_bf16 v10, v48, v69
  v_dot2c_f32_bf16 v11, v33, v69
  v_dot2c_f32_bf16 v12, v48, v70
  v_dot2c_f32_bf16 v13, v33, v70
  v_dot2c_f32_bf16 v14, v48, v71
  v_dot2c_f32_bf16 v15, v33, v71
  s_waitcnt vmcnt(5)
  v_lshrrev_b32 v48, 16, v34
  v_dot2c_f32_bf16 v8, v48, v72
  v_dot2c_f32_bf16 v9, v34, v72
  v_dot2c_f32_bf16 v10, v48, v73
  v_dot2c_f32_bf16 v11, v34, v73
  v_dot2c_f32_bf16 v12, v48, v74
  v_dot2c_f32_bf16 v13, v34, v74
  v_dot2c_f32_bf16 v14, v48, v75
  v_dot2c_f32_bf16 v15, v34, v75
  s_waitcnt vmcnt(4)
  v_lshrrev_b32 v48, 16, v35
  v_dot2c_f32_bf16 v8, v48, v76
  v_dot2c_f32_bf16 v9, v35, v76
  v_dot2c_f32_bf16 v10, v48, v77
  v_dot2c_f32_bf16 v11, v35, v77
  v_dot2c_f32_bf16 v12, v48, v78
  v_dot2c_f32_bf16 v13, v35, v78
  v_dot2c_f32_bf16 v14, v48, v79
  v_dot2c_f32_bf16 v15, v35, v79
  s_waitcnt vmcnt(3)
  v_lshrrev_b32 v48, 16, v36
  v_dot2c_f32_bf16 v8, v48, v80
  v_dot2c_f32_bf16 v9, v36, v80
  v_dot2c_f32_bf16 v10, v48, v81
  v_dot2c_f32_bf16 v11, v36, v81
  v_dot2c_f32_bf16 v12, v48, v82
  v_dot2c_f32_bf16 v13, v36, v82
  v_dot2c_f32_bf16 v14, v48, v83
  v_dot2c_f32_bf16 v15, v36, v83
  s_waitcnt vmcnt(2)
  v_lshrrev_b32 v48, 16, v37
  v_dot2c_f32_bf16 v8, v48, v84
  v_dot2c_f32_bf16 v9, v37, v84
  v_dot2c_f32_bf16 v10, v48, v85
  v_dot2c_f32_bf16 v11, v37, v85
  v_dot2c_f32_bf16 v12, v48, v86
  v_dot2c_f32_bf16 v13, v37, v86
  v_dot2c_f32_bf16 v14, v48, v87
  v_dot2c_f32_bf16 v15, v37, v87
  s_waitcnt vmcnt(1)
  v_lshrrev_b32 v48, 16, v38
  v_dot2c_f32_bf16 v8, v48, v88
  v_dot2c_f32_bf16 v9, v38, v88
  v_dot2c_f32_bf16 v10, v48, v89
  v_dot2c_f32_bf16 v11, v38, v89
  v_dot2c_f32_bf16 v12, v48, v90
  v_dot2c_f32_bf16 v13, v38, v90
  v_dot2c_f32_bf16 v14, v48, v91
  v_dot2c_f32_bf16 v15, v38, v91
  s_waitcnt vmcnt(0)
  v_lshrrev_b32 v48, 16, v39
  v_dot2c_f32_bf16 v8, v48, v92
  v_dot2c_f32_bf16 v9, v39, v92
  v_dot2c_f32_bf16 v10, v48, v93
  v_dot2c_f32_bf16 v11, v39, v93
  v_dot2c_f32_bf16 v12, v48, v94
  v_dot2c_f32_bf16 v13, v39, v94
  v_dot2c_f32_bf16 v14, v48, v95
  v_dot2c_f32_bf16 v15, v39, v95
  s_nop 0
  s_nop 1
  v_permlane32_swap_b32 v8, v12
  v_permlane32_swap_b32 v9, v13
  v_permlane32_swap_b32 v10, v14
  v_permlane32_swap_b32 v11, v15
  v_add_f32 v8, v8, v12
  v_add_f32 v9, v9, v13
  v_add_f32 v10, v10, v14
  v_add_f32 v11, v11, v15
  s_nop 0
  v_permlane16_swap_b32 v8, v10
  v_permlane16_swap_b32 v9, v11
  v_add_f32 v8, v8, v10
  v_add_f32 v9, v9, v11
  ds_write_b64 v50, v[8:9] offset:5120
  s_waitcnt lgkmcnt(0)
  s_barrier
  v_mov_b32 v52, 0
  ds_read_b32 v53, v52 offset:132
  s_cmp_lg_u32 s3, 0
  s_cbranch_scc1 L_s_after_pub
  s_mov_b64 exec, 0xffffffff
  ds_read_b128 v[8:11], v1 offset:5120
  ds_read_b128 v[12:15], v1 offset:5632
  ds_read_b128 v[16:19], v1 offset:6144
  ds_read_b128 v[20:23], v1 offset:6656
  s_waitcnt lgkmcnt(0)
  v_pk_add_f32 v[8:9], v[8:9], v[12:13]
  v_pk_add_f32 v[16:17], v[16:17], v[20:21]
  v_pk_add_f32 v[10:11], v[10:11], v[14:15]
  v_pk_add_f32 v[18:19], v[18:19], v[22:23]
  v_pk_add_f32 v[8:9], v[8:9], v[16:17]
  v_pk_add_f32 v[10:11], v[10:11], v[18:19]
  v_min_u32 v8, -2, v8
  v_min_u32 v9, -2, v9
  v_min_u32 v10, -2, v10
  v_min_u32 v11, -2, v11
  global_store_dwordx4 v51, v[8:11], s[42:43] sc1
  s_nop 1
  s_mov_b64 exec, -1
L_s_after_pub:
  s_waitcnt lgkmcnt(0)
  v_readfirstlane_b32 s57, v53
  s_nop 0
  s_cmp_ge_u32 s57, 56
  s_cbranch_scc1 L_end
  s_mov_b32 s8, s28
  s_mov_b32 s9, s29
  s_mov_b32 s10, 0x1c0000
  s_mov_b32 s11, 0x20000
  s_mov_b32 s12, s30
  s_mov_b32 s13, s31
  s_mov_b32 s14, 0x1c0000
  s_mov_b32 s15, 0x20000
  s_mov_b32 s64, s32
  s_mov_b32 s65, s33
  s_mov_b32 s66, 0x1c0000
  s_mov_b32 s67, 0x20000
  v_lshrrev_b32 v52, 2, v0
  s_lshl_b32 s50, s6, 7
  v_add_u32 v52, s50, v52
  v_and_b32 v53, 3, v0
  v_lshlrev_b32 v53, 4, v53
  s_movk_i32 s50, 3584
  v_mad_u32_u24 v54, v52, s50, v53
  v_lshrrev_b32 v55, 3, v52
  v_lshl_add_u32 v53, v55, 4, v53
  v_lshl_add_u32 v52, v52, 6, v53
  v_add_u32 v52, 78848, v52
  v_add_u32 v53, 33792, v52
  s_lshl_b32 s50, s6, 13
  s_add_u32 s50, s50, 46080
  v_add_u32 v55, s50, v1
  v_mov_b32 v11, 1
  v_mov_b32 v12, 0
  s_lshl_b32 s50, s57, 6
  s_lshl_b32 s51, s57, 5
  s_lshl_b32 s52, s6, 3
  s_add_u32 s51, s51, s52
  s_lshl_b32 s51, s51, 10
  buffer_load_dwordx4 v[64:67], v54, s[8:11], s50 offen nt
  buffer_load_dwordx4 v[68:71], v54, s[12:15], s50 offen nt
  s_add_u32 s50, s50, 57344
  buffer_load_dwordx4 v[72:75], v54, s[8:11], s50 offen nt
  buffer_load_dwordx4 v[76:79], v54, s[12:15], s50 offen nt
  s_add_u32 s50, s50, 57344
  buffer_load_dwordx4 v[80:83], v54, s[8:11], s50 offen nt
  s_waitcnt vmcnt(4)
  ds_write_b128 v52, v[64:67] offset:0
  buffer_load_dwordx4 v[84:87], v54, s[12:15], s50 offen nt
  s_add_u32 s50, s50, 57344
  s_waitcnt vmcnt(4)
  ds_write_b128 v53, v[68:71] offset:0
  buffer_load_dwordx4 v[88:91], v54, s[8:11], s50 offen nt
  s_waitcnt vmcnt(4)
  ds_write_b128 v52, v[72:75] offset:1056
  buffer_load_dwordx4 v[92:95], v54, s[12:15], s50 offen nt
  s_add_u32 s50, s50, 57344
  s_waitcnt vmcnt(4)
  ds_write_b128 v53, v[76:79] offset:1056
  buffer_load_dwordx4 v[96:99], v54, s[8:11], s50 offen nt
  s_waitcnt vmcnt(4)
  ds_write_b128 v52, v[80:83] offset:2112
  buffer_load_dwordx4 v[100:103], v54, s[12:15], s50 offen nt
  s_add_u32 s50, s50, 57344
  s_waitcnt vmcnt(4)
  ds_write_b128 v53, v[84:87] offset:2112
  buffer_load_dwordx4 v[104:107], v54, s[8:11], s50 offen nt
  s_waitcnt vmcnt(4)
  ds_write_b128 v52, v[88:91] offset:3168
  buffer_load_dwordx4 v[108:111], v54, s[12:15], s50 offen nt
  s_add_u32 s50, s50, 57344
  s_waitcnt vmcnt(4)
  ds_write_b128 v53, v[92:95] offset:3168
  s_waitcnt lgkmcnt(0)
  buffer_load_dwordx4 v[112:115], v54, s[8:11], s50 offen nt
  s_waitcnt vmcnt(4)
  ds_write_b128 v52, v[96:99] offset:4224
  buffer_load_dwordx4 v[116:119], v54, s[12:15], s50 offen nt
  s_add_u32 s50, s50, 57344
  s_waitcnt vmcnt(4)
  ds_write_b128 v53, v[100:103] offset:4224
  buffer_load_dwordx4 v[120:123], v54, s[8:11], s50 offen nt
  s_waitcnt vmcnt(4)
  ds_write_b128 v52, v[104:107] offset:5280
  buffer_load_dwordx4 v[124:127], v54, s[12:15], s50 offen nt
  s_add_u32 s50, s50, 57344
  s_waitcnt vmcnt(4)
  ds_write_b128 v53, v[108:111] offset:5280
  buffer_load_dwordx4 v[128:131], v1, s[64:67], s51 offen offset:0 nt
  s_waitcnt vmcnt(4)
  ds_write_b128 v52, v[112:115] offset:6336
  buffer_load_dwordx4 v[132:135], v1, s[64:67], s51 offen offset:1024 nt
  s_waitcnt vmcnt(4)
  ds_write_b128 v53, v[116:119] offset:6336
  buffer_load_dwordx4 v[136:139], v1, s[64:67], s51 offen offset:2048 nt
  s_waitcnt vmcnt(4)
  ds_write_b128 v52, v[120:123] offset:7392
  buffer_load_dwordx4 v[140:143], v1, s[64:67], s51 offen offset:3072 nt
  s_add_u32 s51, s51, 4096
  s_waitcnt vmcnt(4)
  ds_write_b128 v53, v[124:127] offset:7392
  s_waitcnt lgkmcnt(0)
  buffer_load_dwordx4 v[144:147], v1, s[64:67], s51 offen offset:0 nt
  s_waitcnt vmcnt(4)
  ds_write_b128 v55, v[128:131] offset:0
  buffer_load_dwordx4 v[148:151], v1, s[64:67], s51 offen offset:1024 nt
  s_waitcnt vmcnt(4)
  ds_write_b128 v55, v[132:135] offset:1024
  buffer_load_dwordx4 v[152:155], v1, s[64:67], s51 offen offset:2048 nt
  s_waitcnt vmcnt(4)
  ds_write_b128 v55, v[136:139] offset:2048
  buffer_load_dwordx4 v[156:159], v1, s[64:67], s51 offen offset:3072 nt
  s_waitcnt vmcnt(4)
  ds_write_b128 v55, v[140:143] offset:3072
  s_waitcnt vmcnt(3)
  ds_write_b128 v55, v[144:147] offset:4096
  s_waitcnt vmcnt(2)
  ds_write_b128 v55, v[148:151] offset:5120
  s_waitcnt vmcnt(1)
  ds_write_b128 v55, v[152:155] offset:6144
  s_waitcnt vmcnt(0)
  ds_write_b128 v55, v[156:159] offset:7168
  s_waitcnt lgkmcnt(0)
  s_mov_b64 exec, 1
  ds_add_u32 v12, v11 offset:16
  s_mov_b64 exec, -1
  s_mov_b32 s70, 2097152
L_sst_spin:
  ds_read_b32 v13, v12 offset:16
  s_waitcnt lgkmcnt(0)
  v_readfirstlane_b32 s50, v13
  s_sub_u32 s70, s70, 1
  s_cmp_eq_u32 s70, 0
  s_cbranch_scc1 L_sst_done
  s_cmp_ge_u32 s50, 5
  s_cbranch_scc1 L_sst_done
  s_sleep 1
  s_branch L_sst_spin
L_sst_done:
  s_branch L_gather_ap
L_helper:
  v_lshrrev_b32 v1, 2, v0
  v_and_b32 v2, 3, v0
  s_lshl_b32 s7, s6, 7
  v_add_u32 v3, s7, v1
  v_lshlrev_b32 v4, 2, v0
  s_lshl_b32 s50, s6, 8
  v_add_u32 v4, s50, v4
  s_movk_i32 s50, 6144
  v_mul_lo_u32 v5, v3, s50
  v_lshl_add_u32 v5, v2, 4, v5
  v_lshlrev_b32 v6, 4, v0
  s_lshl_b32 s50, s5, 6
  s_lshl_b32 s51, s6, 4
  s_add_u32 s50, s50, s51
  v_lshrrev_b32 v7, 4, v0
  v_lshl_add_u32 v7, v7, 2, s50
  v_lshlrev_b32 v10, 1, v7
  v_lshlrev_b32 v9, 13, v7
  v_and_b32 v11, 15, v0
  v_lshl_add_u32 v9, v11, 4, v9
  v_mov_b32 v8, 0
  s_waitcnt lgkmcnt(0)
  global_load_dword v49, v8, s[42:43]
  s_cmp_ge_u32 s58, 96
  s_cbranch_scc1 L_h_noprod1
  s_mov_b32 s8, s36
  s_mov_b32 s9, s37
  s_mov_b32 s10, 0x300000
  s_mov_b32 s11, 0x20000
  global_load_dword v52, v4, s[34:35]
  s_lshl_b32 s50, s58, 6
  buffer_load_dwordx4 v[192:195], v5, s[8:11], s50 offen nt
  s_add_u32 s50, s50, 98304
  buffer_load_dwordx4 v[196:199], v5, s[8:11], s50 offen nt
  s_add_u32 s50, s50, 98304
  buffer_load_dwordx4 v[200:203], v5, s[8:11], s50 offen nt
  s_add_u32 s50, s50, 98304
  buffer_load_dwordx4 v[204:207], v5, s[8:11], s50 offen nt
  s_add_u32 s50, s50, 98304
  buffer_load_dwordx4 v[208:211], v5, s[8:11], s50 offen nt
  s_add_u32 s50, s50, 98304
  buffer_load_dwordx4 v[212:215], v5, s[8:11], s50 offen nt
  s_add_u32 s50, s50, 98304
  buffer_load_dwordx4 v[216:219], v5, s[8:11], s50 offen nt
  s_add_u32 s50, s50, 98304
  buffer_load_dwordx4 v[220:223], v5, s[8:11], s50 offen nt
L_h_noprod1:
  s_lshl_b32 s50, s5, 3
  s_add_u32 s50, s50, s3
  s_cmp_lg_u32 s50, 4
  s_cbranch_scc1 L_h_nocinit
  v_bfe_u32 v11, v0, 3, 1
  v_lshlrev_b32 v11, 7, v11
  v_and_b32 v12, 7, v0
  v_lshl_add_u32 v11, v12, 2, v11
  s_lshl_b32 s50, s4, 8
  s_add_u32 s50, s50, 32768
  v_add_u32 v11, s50, v11
  s_mov_b64 exec, 0xffff
  global_store_dword v11, v8, s[42:43] sc1
  s_mov_b64 exec, -1
L_h_nocinit:
  global_load_dwordx4 v[56:59], v6, s[16:17]
  global_load_dwordx2 v[46:47], v10, s[16:17]
  s_mov_b32 s12, s22
  s_mov_b32 s13, s23
  s_mov_b32 s14, 0x400000
  s_mov_b32 s15, 0x20000
  s_lshl_b32 s50, s4, 8
  buffer_load_dwordx4 v[64:67], v9, s[12:15], s50 offen nt
  s_add_u32 s50, s50, 8192
  buffer_load_dwordx4 v[68:71], v9, s[12:15], s50 offen nt
  s_add_u32 s50, s50, 8192
  buffer_load_dwordx4 v[72:75], v9, s[12:15], s50 offen nt
  s_add_u32 s50, s50, 8192
  buffer_load_dwordx4 v[76:79], v9, s[12:15], s50 offen nt
  s_cmp_lg_u32 s3, 4
  s_cbranch_scc1 L_h_nozero
  v_lshlrev_b32 v10, 2, v0
  ds_write_b32 v10, v8 offset:0
  s_lshl_b32 s50, s2, 21
  v_lshlrev_b32 v11, 15, v0
  v_add_u32 v11, s50, v11
  v_mov_b32 v12, -1
  v_cmp_gt_u32 vcc, 60, v0
  s_nop 1
  v_cndmask_b32 v11, v12, v11, vcc
  ds_write_b32 v10, v11 offset:12032
  ds_write_b32 v10, v12 offset:12288
  ds_write_b32 v10, v11 offset:12544
  ds_write_b32 v10, v12 offset:12800
  s_waitcnt lgkmcnt(0)
L_h_nozero:
  s_barrier
  s_cmp_ge_u32 s58, 96
  s_cbranch_scc1 L_h_w1
  s_waitcnt vmcnt(14)
  s_branch L_h_w2
L_h_w1:
  s_waitcnt vmcnt(4)
L_h_w2:
  s_mov_b32 s50, 0x9e3779b1
  v_mul_lo_u32 v49, v49, s50
  v_add_u32 v49, 0x7f4a7c15, v49
  v_mov_b32 v10, s6
  v_lshlrev_b32 v10, 2, v10
  ds_write_b32 v10, v49 offset:256
  s_cmp_ge_u32 s58, 96
  s_cbranch_scc1 L_h_noprod2
  v_lshlrev_b32 v32, 16, v52
  v_and_b32 v33, 0xffff0000, v52
  v_mul_f32 v80, 0xbfb8aa3b, v32
  v_mul_f32 v81, 0xbfb8aa3b, v33
  v_min_f32 v112, 0x42fc0000, v80
  v_min_f32 v113, 0x42fc0000, v81
  v_exp_f32 v112, v112
  v_exp_f32 v113, v113
  v_add_f32 v112, 1.0, v112
  v_add_f32 v113, 1.0, v113
  v_rcp_f32 v96, v112
  v_rcp_f32 v97, v113
  v_mul_f32 v88, v32, v96
  v_mul_f32 v89, v33, v97
  v_fma_f32 v104, -v88, v112, v32
  v_fma_f32 v105, -v89, v113, v33
  v_fma_f32 v88, v104, v96, v88
  v_fma_f32 v89, v105, v97, v89
  v_cvt_pk_bf16_f32 v88, 0, v88
  v_cvt_pk_bf16_f32 v89, 0, v89
  v_and_b32 v10, 7, v0
  v_lshlrev_b32 v10, 6, v10
  v_lshrrev_b32 v11, 3, v0
  v_lshl_add_u32 v10, v11, 2, v10
  s_lshl_b32 s50, s6, 9
  v_add_u32 v10, s50, v10
  ds_write_b32 v10, v88 offset:3072
  ds_write_b32 v10, v89 offset:3104
  v_lshl_add_u32 v10, v1, 5, s50
  ds_read_b128 v[16:19], v10 offset:3072
  ds_read_b128 v[20:23], v10 offset:3088
  s_waitcnt vmcnt(6) lgkmcnt(0)
  v_mov_b32 v24, 0
  v_lshrrev_b32 v80, 16, v16
  v_mov_b32 v25, 0
  v_lshrrev_b32 v81, 16, v17
  v_mov_b32 v26, 0
  v_lshrrev_b32 v82, 16, v18
  v_mov_b32 v27, 0
  v_lshrrev_b32 v83, 16, v19
  v_mov_b32 v28, 0
  v_lshrrev_b32 v84, 16, v20
  v_mov_b32 v29, 0
  v_lshrrev_b32 v85, 16, v21
  v_mov_b32 v30, 0
  v_lshrrev_b32 v86, 16, v22
  v_mov_b32 v31, 0
  v_lshrrev_b32 v87, 16, v23
  v_dot2c_f32_bf16 v24, v80, v192
  v_dot2c_f32_bf16 v25, v16, v192
  v_dot2c_f32_bf16 v26, v80, v193
  v_dot2c_f32_bf16 v27, v16, v193
  v_dot2c_f32_bf16 v28, v80, v194
  v_dot2c_f32_bf16 v29, v16, v194
  v_dot2c_f32_bf16 v30, v80, v195
  v_dot2c_f32_bf16 v31, v16, v195
  v_dot2c_f32_bf16 v24, v81, v196
  v_dot2c_f32_bf16 v25, v17, v196
  v_dot2c_f32_bf16 v26, v81, v197
  v_dot2c_f32_bf16 v27, v17, v197
  v_dot2c_f32_bf16 v28, v81, v198
  v_dot2c_f32_bf16 v29, v17, v198
  v_dot2c_f32_bf16 v30, v81, v199
  v_dot2c_f32_bf16 v31, v17, v199
  v_dot2c_f32_bf16 v24, v82, v200
  v_dot2c_f32_bf16 v25, v18, v200
  v_dot2c_f32_bf16 v26, v82, v201
  v_dot2c_f32_bf16 v27, v18, v201
  v_dot2c_f32_bf16 v28, v82, v202
  v_dot2c_f32_bf16 v29, v18, v202
  v_dot2c_f32_bf16 v30, v82, v203
  v_dot2c_f32_bf16 v31, v18, v203
  v_dot2c_f32_bf16 v24, v83, v204
  v_dot2c_f32_bf16 v25, v19, v204
  v_dot2c_f32_bf16 v26, v83, v205
  v_dot2c_f32_bf16 v27, v19, v205
  v_dot2c_f32_bf16 v28, v83, v206
  v_dot2c_f32_bf16 v29, v19, v206
  v_dot2c_f32_bf16 v30, v83, v207
  v_dot2c_f32_bf16 v31, v19, v207
  v_dot2c_f32_bf16 v24, v84, v208
  v_dot2c_f32_bf16 v25, v20, v208
  v_dot2c_f32_bf16 v26, v84, v209
  v_dot2c_f32_bf16 v27, v20, v209
  v_dot2c_f32_bf16 v28, v84, v210
  v_dot2c_f32_bf16 v29, v20, v210
  v_dot2c_f32_bf16 v30, v84, v211
  v_dot2c_f32_bf16 v31, v20, v211
  v_dot2c_f32_bf16 v24, v85, v212
  v_dot2c_f32_bf16 v25, v21, v212
  v_dot2c_f32_bf16 v26, v85, v213
  v_dot2c_f32_bf16 v27, v21, v213
  v_dot2c_f32_bf16 v28, v85, v214
  v_dot2c_f32_bf16 v29, v21, v214
  v_dot2c_f32_bf16 v30, v85, v215
  v_dot2c_f32_bf16 v31, v21, v215
  v_dot2c_f32_bf16 v24, v86, v216
  v_dot2c_f32_bf16 v25, v22, v216
  v_dot2c_f32_bf16 v26, v86, v217
  v_dot2c_f32_bf16 v27, v22, v217
  v_dot2c_f32_bf16 v28, v86, v218
  v_dot2c_f32_bf16 v29, v22, v218
  v_dot2c_f32_bf16 v30, v86, v219
  v_dot2c_f32_bf16 v31, v22, v219
  v_dot2c_f32_bf16 v24, v87, v220
  v_dot2c_f32_bf16 v25, v23, v220
  v_dot2c_f32_bf16 v26, v87, v221
  v_dot2c_f32_bf16 v27, v23, v221
  v_dot2c_f32_bf16 v28, v87, v222
  v_dot2c_f32_bf16 v29, v23, v222
  v_dot2c_f32_bf16 v30, v87, v223
  v_dot2c_f32_bf16 v31, v23, v223
  v_lshrrev_b32 v10, 4, v0
  v_lshlrev_b32 v10, 3, v10
  v_lshl_add_u32 v10, v2, 5, v10
  v_add_u32 v10, s7, v10
  s_nop 1
  v_permlane32_swap_b32 v24, v28
  v_permlane32_swap_b32 v25, v29
  v_permlane32_swap_b32 v26, v30
  v_permlane32_swap_b32 v27, v31
  v_add_f32 v24, v24, v28
  v_add_f32 v25, v25, v29
  v_add_f32 v26, v26, v30
  v_add_f32 v27, v27, v31
  s_nop 0
  v_permlane16_swap_b32 v24, v26
  v_permlane16_swap_b32 v25, v27
  v_add_f32 v24, v24, v26
  v_add_f32 v25, v25, v27
  s_nop 0
  v_add_f32_dpp v24, v24, v24 row_ror:8 row_mask:0xf bank_mask:0xf
  v_add_f32_dpp v25, v25, v25 row_ror:8 row_mask:0xf bank_mask:0xf
  s_nop 0
  v_add_f32_dpp v24, v24, v24 row_ror:4 row_mask:0xf bank_mask:0xf
  v_add_f32_dpp v25, v25, v25 row_ror:4 row_mask:0xf bank_mask:0xf
  ds_write_b64 v10, v[24:25] offset:512
  v_mov_b32 v11, 1
  v_mov_b32 v12, 0
  s_mov_b64 exec, 1
  ds_add_rtn_u32 v13, v12, v11 offset:0
  s_mov_b64 exec, -1
  s_waitcnt lgkmcnt(0)
  v_readfirstlane_b32 s50, v13
  s_nop 0
  s_cmp_lg_u32 s50, 3
  s_cbranch_scc1 L_h_noprod2
  v_and_b32 v11, 7, v0
  v_lshlrev_b32 v11, 4, v11
  ds_read_b128 v[16:19], v11 offset:512
  ds_read_b128 v[20:23], v11 offset:640
  ds_read_b128 v[24:27], v11 offset:768
  ds_read_b128 v[28:31], v11 offset:896
  s_lshl_b32 s50, s58, 7
  s_add_u32 s50, s50, 4096
  v_add_u32 v10, s50, v11
  s_mov_b64 exec, 0xff
  s_waitcnt lgkmcnt(0)
  v_pk_add_f32 v[16:17], v[16:17], v[20:21]
  v_pk_add_f32 v[24:25], v[24:25], v[28:29]
  v_pk_add_f32 v[18:19], v[18:19], v[22:23]
  v_pk_add_f32 v[26:27], v[26:27], v[30:31]
  v_pk_add_f32 v[16:17], v[16:17], v[24:25]
  v_pk_add_f32 v[18:19], v[18:19], v[26:27]
  v_cvt_pk_bf16_f32 v16, v16, v17
  v_cvt_pk_bf16_f32 v18, v18, v19
  v_mov_b32 v17, v49
  v_mov_b32 v19, v49
  global_store_dwordx4 v10, v[16:19], s[42:43] sc1
  s_nop 1
  s_mov_b64 exec, -1
L_h_noprod2:
  s_waitcnt vmcnt(4)
  v_lshlrev_b32 v16, 16, v56
  v_and_b32 v17, 0xffff0000, v56
  v_lshlrev_b32 v18, 16, v57
  v_and_b32 v19, 0xffff0000, v57
  v_lshlrev_b32 v20, 16, v58
  v_and_b32 v21, 0xffff0000, v58
  v_lshlrev_b32 v22, 16, v59
  v_and_b32 v23, 0xffff0000, v59
  v_pk_add_f32 v[32:33], v[16:17], v[18:19]
  v_pk_add_f32 v[34:35], v[20:21], v[22:23]
  v_pk_add_f32 v[32:33], v[32:33], v[34:35]
  v_add_f32 v32, v32, v33
  s_nop 1
  v_add_f32_dpp v32, v32, v32 row_ror:8 row_mask:0xf bank_mask:0xf
  s_nop 1
  v_add_f32_dpp v32, v32, v32 row_ror:4 row_mask:0xf bank_mask:0xf
  s_nop 1
  v_add_f32_dpp v32, v32, v32 row_ror:2 row_mask:0xf bank_mask:0xf
  s_nop 1
  v_add_f32_dpp v32, v32, v32 row_ror:1 row_mask:0xf bank_mask:0xf
  v_mov_b32 v33, v32
  s_nop 1
  v_permlane16_swap_b32 v32, v33
  v_add_f32 v32, v32, v33
  v_mov_b32 v33, v32
  s_nop 1
  v_permlane32_swap_b32 v32, v33
  v_add_f32 v32, v32, v33
  v_mul_f32 v32, 0x3b000000, v32
  v_cvt_pk_bf16_f32 v40, 0, v32
  v_sub_f32 v34, v16, v32
  v_sub_f32 v35, v17, v32
  v_sub_f32 v36, v18, v32
  v_sub_f32 v37, v19, v32
  v_mul_f32 v38, v34, v34
  v_mul_f32 v39, v35, v35
  v_fmac_f32 v38, v36, v36
  v_fmac_f32 v39, v37, v37
  v_sub_f32 v34, v20, v32
  v_sub_f32 v35, v21, v32
  v_sub_f32 v36, v22, v32
  v_sub_f32 v37, v23, v32
  v_fmac_f32 v38, v34, v34
  v_fmac_f32 v39, v35, v35
  v_fmac_f32 v38, v36, v36
  v_fmac_f32 v39, v37, v37
  v_add_f32 v34, v38, v39
  s_nop 1
  v_add_f32_dpp v34, v34, v34 row_ror:8 row_mask:0xf bank_mask:0xf
  s_nop 1
  v_add_f32_dpp v34, v34, v34 row_ror:4 row_mask:0xf bank_mask:0xf
  s_nop 1
  v_add_f32_dpp v34, v34, v34 row_ror:2 row_mask:0xf bank_mask:0xf
  s_nop 1
  v_add_f32_dpp v34, v34, v34 row_ror:1 row_mask:0xf bank_mask:0xf
  v_mov_b32 v33, v34
  s_nop 1
  v_permlane16_swap_b32 v34, v33
  v_add_f32 v34, v34, v33
  v_mov_b32 v33, v34
  s_nop 1
  v_permlane32_swap_b32 v34, v33
  v_add_f32 v34, v34, v33
  v_mul_f32 v34, 0x3b000000, v34
  v_cvt_pk_bf16_f32 v34, 0, v34
  v_add_f32 v34, 0x3727c5ac, v34
  v_cvt_pk_bf16_f32 v34, 0, v34
  v_sqrt_f32 v32, v34
  s_nop 0
  v_rcp_f32 v33, v32
  v_fma_f32 v35, -v32, v32, v34
  v_mul_f32 v33, 0.5, v33
  v_fma_f32 v32, v35, v33, v32
  v_cvt_pk_bf16_f32 v41, 0, v32
  v_rcp_f32 v42, v41
  s_mov_b32 s50, 4096
  v_lshlrev_b32 v10, 2, v7
  v_add_u32 v10, s50, v10
  v_lshlrev_b32 v16, 16, v46
  v_and_b32 v17, 0xffff0000, v46
  v_lshlrev_b32 v18, 16, v47
  v_and_b32 v19, 0xffff0000, v47
  s_mov_b64 s[68:69], exec
  s_mov_b32 s70, 131072
L_poll_1:
  global_load_dwordx4 v[24:27], v10, s[42:43] sc1
  global_load_dwordx4 v[28:31], v10, s[42:43] offset:2048 sc1
  s_waitcnt vmcnt(0)
  v_cmp_ne_u32 vcc, v25, v49
  v_cmp_ne_u32 s[60:61], v27, v49
  s_or_b64 vcc, vcc, s[60:61]
  v_cmp_ne_u32 s[60:61], v29, v49
  s_or_b64 vcc, vcc, s[60:61]
  v_cmp_ne_u32 s[60:61], v31, v49
  s_or_b64 vcc, vcc, s[60:61]
  s_cbranch_vccz L_poll_done_2
  s_mov_b64 exec, vcc
  s_sub_u32 s70, s70, 1
  s_cmp_eq_u32 s70, 0
  s_cbranch_scc1 L_poll_done_2
  s_sleep 2
  s_branch L_poll_1
L_poll_done_2:
  s_mov_b64 exec, s[68:69]
  v_lshlrev_b32 v20, 16, v24
  v_and_b32 v21, 0xffff0000, v24
  v_lshlrev_b32 v22, 16, v26
  v_and_b32 v23, 0xffff0000, v26
  v_lshlrev_b32 v32, 16, v28
  v_and_b32 v33, 0xffff0000, v28
  v_lshlrev_b32 v34, 16, v30
  v_and_b32 v35, 0xffff0000, v30
  v_add_f32 v32, 1.0, v32
  v_add_f32 v33, 1.0, v33
  v_add_f32 v34, 1.0, v34
  v_add_f32 v35, 1.0, v35
  v_cvt_pk_bf16_f32 v32, 0, v32
  v_cvt_pk_bf16_f32 v33, 0, v33
  v_cvt_pk_bf16_f32 v34, 0, v34
  v_cvt_pk_bf16_f32 v35, 0, v35
  v_sub_f32 v80, v16, v40
  v_sub_f32 v81, v17, v40
  v_sub_f32 v82, v18, v40
  v_sub_f32 v83, v19, v40
  v_cvt_pk_bf16_f32 v80, 0, v80
  v_cvt_pk_bf16_f32 v81, 0, v81
  v_cvt_pk_bf16_f32 v82, 0, v82
  v_cvt_pk_bf16_f32 v83, 0, v83
  v_mul_f32 v36, v80, v42
  v_mul_f32 v37, v81, v42
  v_mul_f32 v38, v82, v42
  v_mul_f32 v39, v83, v42
  v_fma_f32 v84, -v36, v41, v80
  v_fma_f32 v85, -v37, v41, v81
  v_fma_f32 v86, -v38, v41, v82
  v_fma_f32 v87, -v39, v41, v83
  v_fma_f32 v36, v84, v42, v36
  v_fma_f32 v37, v85, v42, v37
  v_fma_f32 v38, v86, v42, v38
  v_fma_f32 v39, v87, v42, v39
  v_cvt_pk_bf16_f32 v36, 0, v36
  v_cvt_pk_bf16_f32 v37, 0, v37
  v_cvt_pk_bf16_f32 v38, 0, v38
  v_cvt_pk_bf16_f32 v39, 0, v39
  v_mul_f32 v36, v36, v32
  v_mul_f32 v37, v37, v33
  v_mul_f32 v38, v38, v34
  v_mul_f32 v39, v39, v35
  v_cvt_pk_bf16_f32 v36, 0, v36
  v_cvt_pk_bf16_f32 v37, 0, v37
  v_cvt_pk_bf16_f32 v38, 0, v38
  v_cvt_pk_bf16_f32 v39, 0, v39
  v_add_f32 v36, v36, v20
  v_add_f32 v37, v37, v21
  v_add_f32 v38, v38, v22
  v_add_f32 v39, v39, v23
  v_cvt_pk_bf16_f32 v36, 0, v36
  v_cvt_pk_bf16_f32 v37, 0, v37
  v_cvt_pk_bf16_f32 v38, 0, v38
  v_cvt_pk_bf16_f32 v39, 0, v39
  v_mov_b32 v24, 0
  v_mov_b32 v25, 0
  v_mov_b32 v26, 0
  v_mov_b32 v27, 0
  v_mov_b32 v28, 0
  v_mov_b32 v29, 0
  v_mov_b32 v30, 0
  v_mov_b32 v31, 0
  v_lshrrev_b32 v80, 16, v36
  v_lshrrev_b32 v81, 16, v37
  v_lshrrev_b32 v82, 16, v38
  v_lshrrev_b32 v83, 16, v39
  v_dot2c_f32_bf16 v24, v80, v64
  v_dot2c_f32_bf16 v25, v36, v64
  v_dot2c_f32_bf16 v26, v80, v65
  v_dot2c_f32_bf16 v27, v36, v65
  v_dot2c_f32_bf16 v28, v80, v66
  v_dot2c_f32_bf16 v29, v36, v66
  v_dot2c_f32_bf16 v30, v80, v67
  v_dot2c_f32_bf16 v31, v36, v67
  v_dot2c_f32_bf16 v24, v81, v68
  v_dot2c_f32_bf16 v25, v37, v68
  v_dot2c_f32_bf16 v26, v81, v69
  v_dot2c_f32_bf16 v27, v37, v69
  v_dot2c_f32_bf16 v28, v81, v70
  v_dot2c_f32_bf16 v29, v37, v70
  v_dot2c_f32_bf16 v30, v81, v71
  v_dot2c_f32_bf16 v31, v37, v71
  v_dot2c_f32_bf16 v24, v82, v72
  v_dot2c_f32_bf16 v25, v38, v72
  v_dot2c_f32_bf16 v26, v82, v73
  v_dot2c_f32_bf16 v27, v38, v73
  v_dot2c_f32_bf16 v28, v82, v74
  v_dot2c_f32_bf16 v29, v38, v74
  v_dot2c_f32_bf16 v30, v82, v75
  v_dot2c_f32_bf16 v31, v38, v75
  v_dot2c_f32_bf16 v24, v83, v76
  v_dot2c_f32_bf16 v25, v39, v76
  v_dot2c_f32_bf16 v26, v83, v77
  v_dot2c_f32_bf16 v27, v39, v77
  v_dot2c_f32_bf16 v28, v83, v78
  v_dot2c_f32_bf16 v29, v39, v78
  v_dot2c_f32_bf16 v30, v83, v79
  v_dot2c_f32_bf16 v31, v39, v79
  v_and_b32 v10, 15, v0
  v_lshlrev_b32 v10, 5, v10
  v_lshrrev_b32 v11, 4, v0
  v_lshl_add_u32 v10, v11, 3, v10
  s_lshl_b32 s50, s6, 9
  v_add_u32 v10, s50, v10
  s_nop 1
  v_permlane32_swap_b32 v24, v28
  v_permlane32_swap_b32 v25, v29
  v_permlane32_swap_b32 v26, v30
  v_permlane32_swap_b32 v27, v31
  v_add_f32 v24, v24, v28
  v_add_f32 v25, v25, v29
  v_add_f32 v26, v26, v30
  v_add_f32 v27, v27, v31
  s_nop 0
  v_permlane16_swap_b32 v24, v26
  v_permlane16_swap_b32 v25, v27
  v_add_f32 v24, v24, v26
  v_add_f32 v25, v25, v27
  ds_write_b64 v10, v[24:25] offset:3072
  v_lshlrev_b32 v10, 3, v0
  v_mov_b32 v11, 1
  v_mov_b32 v12, 0
  s_mov_b64 exec, 1
  ds_add_rtn_u32 v13, v12, v11 offset:4
  s_mov_b64 exec, -1
  s_waitcnt lgkmcnt(0)
  v_readfirstlane_b32 s50, v13
  s_nop 0
  s_cmp_lg_u32 s50, 3
  s_cbranch_scc1 L_h_noqpub
  ds_read_b64 v[16:17], v10 offset:3072
  ds_read_b64 v[18:19], v10 offset:3584
  ds_read_b64 v[20:21], v10 offset:4096
  ds_read_b64 v[22:23], v10 offset:4608
  s_lshl_b32 s50, s2, 10
  s_add_u32 s50, s50, 393216
  v_add_u32 v10, s50, v6
  s_waitcnt lgkmcnt(0)
  v_pk_add_f32 v[16:17], v[16:17], v[18:19]
  v_pk_add_f32 v[20:21], v[20:21], v[22:23]
  v_pk_add_f32 v[16:17], v[16:17], v[20:21]
  v_mov_b32 v19, v49
  v_mov_b32 v18, v17
  v_mov_b32 v17, v49
  global_store_dwordx4 v10, v[16:19], s[42:43] sc1
  s_nop 1
L_h_noqpub:
  s_lshl_b32 s50, s4, 13
  s_lshl_b32 s51, s6, 8
  s_add_u32 s50, s50, s51
  s_add_u32 s50, s50, 393216
  v_lshrrev_b32 v10, 3, v0
  v_lshlrev_b32 v10, 10, v10
  v_and_b32 v11, 7, v0
  v_lshl_add_u32 v10, v11, 5, v10
  v_add_u32 v10, s50, v10
  v_lshlrev_b32 v48, 4, v11
  v_bfe_u32 v13, v0, 5, 1
  v_lshl_add_u32 v48, v13, 3, v48
  v_bfe_u32 v13, v0, 4, 1
  v_lshl_add_u32 v48, v13, 2, v48
  v_add_u32 v12, s7, v48
  s_mov_b64 s[68:69], exec
  s_mov_b32 s70, 131072
L_poll_3:
  global_load_dwordx4 v[24:27], v10, s[42:43] sc1
  global_load_dwordx4 v[28:31], v10, s[42:43] offset:16 sc1
  s_waitcnt vmcnt(0)
  v_cmp_ne_u32 vcc, v25, v49
  v_cmp_ne_u32 s[60:61], v27, v49
  s_or_b64 vcc, vcc, s[60:61]
  v_cmp_ne_u32 s[60:61], v29, v49
  s_or_b64 vcc, vcc, s[60:61]
  v_cmp_ne_u32 s[60:61], v31, v49
  s_or_b64 vcc, vcc, s[60:61]
  s_cbranch_vccz L_poll_done_4
  s_mov_b64 exec, vcc
  s_sub_u32 s70, s70, 1
  s_cmp_eq_u32 s70, 0
  s_cbranch_scc1 L_poll_done_4
  s_sleep 2
  s_branch L_poll_3
L_poll_done_4:
  s_mov_b64 exec, s[68:69]
  v_permlane32_swap_b32 v24, v28
  v_permlane32_swap_b32 v26, v30
  v_add_f32 v24, v24, v28
  v_add_f32 v26, v26, v30
  s_nop 1
  v_permlane16_swap_b32 v24, v26
  v_add_f32 v24, v24, v26
  s_nop 1
  v_add_f32_dpp v24, v24, v24 row_ror:8 row_mask:0xf bank_mask:0xf
  ds_write_b32 v12, v24 offset:1024
  s_waitcnt lgkmcnt(0)
  s_barrier
  s_cmp_lg_u32 s3, 7
  s_cbranch_scc1 L_h_noclear
  v_mov_b32 v16, -1
  v_mov_b32 v17, -1
  v_mov_b32 v18, -1
  v_mov_b32 v19, -1
  s_lshl_b32 s51, s2, 9
  s_add_u32 s51, s51, 65536
  v_add_u32 v10, s51, v6
  v_and_b32 v11, 15, v0
  v_lshlrev_b32 v11, 4, v11
  v_lshrrev_b32 v12, 4, v0
  v_lshl_add_u32 v11, v12, 16, v11
  s_lshl_b32 s51, s2, 8
  s_add_u32 s51, s51, 196608
  v_add_u32 v11, s51, v11
  v_add_u32 v12, 0x40000, v11
  s_mov_b64 exec, 0xffffffff
  global_store_dwordx4 v10, v[16:19], s[42:43] sc1
  s_nop 1
  s_mov_b64 exec, 0xffff
  global_store_dwordx4 v11, v[16:19], s[42:43] sc1
  s_nop 1
  s_mov_b64 exec, -1
  s_cmp_ge_u32 s2, 56
  s_cbranch_scc1 L_h_noclear
  s_lshl_b32 s51, s2, 11
  s_add_u32 s51, s51, 262144
  v_add_u32 v10, s51, v6
  global_store_dwordx4 v10, v[16:19], s[42:43] sc1
  s_nop 1
  global_store_dwordx4 v10, v[16:19], s[42:43] offset:1024 sc1
  s_nop 1
L_h_noclear:
  s_mov_b32 s8, s24
  s_mov_b32 s9, s25
  s_mov_b32 s10, 0x400000
  s_mov_b32 s11, 0x20000
  v_lshrrev_b32 v10, 3, v0
  v_lshlrev_b32 v10, 2, v10
  s_lshl_b32 s50, s4, 7
  s_lshl_b32 s51, s6, 5
  s_add_u32 s50, s50, s51
  v_add_u32 v10, s50, v10
  v_lshlrev_b32 v10, 10, v10
  v_and_b32 v11, 7, v0
  v_lshl_add_u32 v10, v11, 4, v10
  s_lshl_b32 s50, s5, 7
  buffer_load_dwordx4 v[64:67], v10, s[8:11], s50 offen offset:0 nt
  buffer_load_dwordx4 v[68:71], v10, s[8:11], s50 offen offset:1024 nt
  buffer_load_dwordx4 v[72:75], v10, s[8:11], s50 offen offset:2048 nt
  buffer_load_dwordx4 v[76:79], v10, s[8:11], s50 offen offset:3072 nt
  s_waitcnt vmcnt(0) lgkmcnt(0)
  v_mov_b32 v12, s6
  v_lshlrev_b32 v12, 2, v12
  s_lshl_b32 s59, s4, 24
  v_mov_b32 v17, 0
  s_cmp_lg_u32 s3, 4
  s_cbranch_scc1 L_nosched
  s_lshl_b32 s50, s4, 8
  s_add_u32 s50, s50, 32768
  v_lshl_add_u32 v16, v0, 2, s50
  s_mov_b32 s66, s5
  s_mov_b32 s67, 0
  s_mov_b32 s88, 2
  s_mov_b32 s90, 0
  s_mov_b32 s52, 60
  s_mov_b32 s70, 2097152
L_sch_wait:
  ds_read_b128 v[20:23], v17 offset:96
  s_waitcnt lgkmcnt(0)
  v_max3_u32 v20, v20, v21, v22
  v_max_u32 v20, v20, v23
  s_nop 0
  v_readfirstlane_b32 s50, v20
  s_sub_u32 s70, s70, 1
  s_cmp_eq_u32 s70, 0
  s_cbranch_scc1 L_sch_done
  s_cmp_eq_u32 s67, 0
  s_cselect_b32 s55, 5, 3
  s_add_u32 s50, s50, s55
  s_cmp_ge_u32 s50, s52
  s_cbranch_scc1 L_sch_claim
  s_sub_u32 s50, s52, s50
  s_cmp_gt_u32 s50, 4
  s_cbranch_scc1 L_sch_long
  s_sleep 2
  s_branch L_sch_wait
L_sch_long:
  s_sleep 32
  s_branch L_sch_wait
L_sch_claim:
  s_cmp_ge_u32 s52, 94
  s_cbranch_scc1 L_sch_done
  s_cmp_lg_u32 s90, 0
  s_cbranch_scc1 L_ci_5
  v_mov_b32 v18, s88
  s_lshl_b32 s60, 1, s66
  s_mov_b32 s61, 0
  s_mov_b64 exec, s[60:61]
  global_atomic_add v19, v16, v18, s[42:43] sc0 sc1
  s_branch L_ci_6
L_ci_5:
  s_mov_b64 exec, 0xff
  global_load_dword v15, v16, s[42:43] sc1
L_ci_6:
  s_mov_b64 exec, -1
  s_lshl_b32 s55, s52, 2
  v_mov_b32 v21, s55
  s_waitcnt vmcnt(0)
  s_cmp_lg_u32 s90, 0
  s_cbranch_scc1 L_sch_put_snap
  v_readlane_b32 s53, v19, s66
  s_lshl_b32 s61, 1, s66
  s_cmp_lt_u32 s53, 4
  s_cbranch_scc0 L_sch_put_miss
  s_sub_u32 s54, 4, s53
  s_min_u32 s54, s54, s88
  s_add_u32 s60, s53, s54
  s_cmp_lt_u32 s60, 2
  s_cselect_b32 s88, s88, 1
  s_cmp_lg_u32 s66, s5
  s_cselect_b32 s90, 1, 0
  s_cmp_ge_u32 s60, 4
  s_cselect_b32 s90, 1, s90
  s_cselect_b32 s61, s61, 0
  s_or_b32 s67, s67, s61
  s_lshl_b32 s60, s66, 6
  s_add_u32 s53, s53, s60
  s_add_u32 s53, s53, 60
  s_branch L_sch_put
L_sch_put_miss:
  s_or_b32 s67, s67, s61
  s_mov_b32 s88, 1
  s_mov_b32 s90, 1
  s_branch L_sch_claim
L_sch_put_snap:
  v_cmp_gt_u32 vcc, 4, v15
  s_mov_b32 s90, 0
  s_mov_b32 s88, 1
  s_andn2_b32 s60, vcc_lo, s67
  s_and_b32 s60, s60, 0xff
  s_cbranch_scc0 L_sch_done
  s_lshl_b32 s61, s60, 8
  s_or_b32 s60, s60, s61
  s_lshr_b32 s60, s60, s5
  s_ff1_i32_b32 s60, s60
  s_add_u32 s66, s60, s5
  s_and_b32 s66, s66, 7
  s_branch L_sch_claim
L_sch_put:
  s_lshl_b32 s55, s53, 15
  s_add_u32 s55, s55, s59
  v_mov_b32 v20, s55
  ds_write_b32 v21, v20 offset:12032
  v_add_u32 v21, 4, v21
  s_add_u32 s52, s52, 1
  s_add_u32 s53, s53, 1
  s_sub_u32 s54, s54, 1
  s_cmp_lg_u32 s54, 0
  s_cbranch_scc1 L_sch_put
  s_branch L_sch_wait
L_sch_done:
  s_lshl_b32 s55, s52, 2
  v_mov_b32 v21, s55
  v_mov_b32 v20, -2
  ds_write_b32 v21, v20 offset:12032
L_nosched:
  s_lshl_b32 s50, s4, 9
  s_add_u32 s50, s50, 16384
  v_and_b32 v11, 31, v0
  v_lshlrev_b32 v11, 4, v11
  v_add_u32 v11, s50, v11
  s_lshl_b32 s50, s6, 14
  s_add_u32 s50, s50, 13312
  v_add_u32 v10, s50, v6
  s_mov_b32 s51, 0x3fb8aa3b
  s_mov_b32 s70, 2097152
L_kd_spin:
  ds_read_b32 v13, v12 offset:64
  s_waitcnt lgkmcnt(0)
  v_readfirstlane_b32 s52, v13
  s_sub_u32 s70, s70, 1
  s_cmp_eq_u32 s70, 0
  s_cbranch_scc1 L_kd_done
  s_cmp_lg_u32 s52, 0
  s_cbranch_scc1 L_kd_done
  s_sleep 8
  s_branch L_kd_spin
L_kd_done:
  ds_read_b128 v[192:195], v10 offset:0
  ds_read_b128 v[196:199], v10 offset:1024
  ds_read_b128 v[200:203], v10 offset:2048
  ds_read_b128 v[204:207], v10 offset:3072
  ds_read_b128 v[208:211], v10 offset:4096
  ds_read_b128 v[212:215], v10 offset:5120
  ds_read_b128 v[216:219], v10 offset:6144
  ds_read_b128 v[220:223], v10 offset:7168
  ds_read_b128 v[224:227], v10 offset:8192
  ds_read_b128 v[228:231], v10 offset:9216
  ds_read_b128 v[232:235], v10 offset:10240
  ds_read_b128 v[236:239], v10 offset:11264
  s_mov_b64 s[68:69], exec
  s_mov_b32 s70, 131072
L_poll_7:
  global_load_dwordx4 v[28:31], v11, s[42:43] sc1
  s_waitcnt vmcnt(0)
  v_cmp_ne_u32 vcc, v29, v49
  v_cmp_ne_u32 s[60:61], v31, v49
  s_or_b64 vcc, vcc, s[60:61]
  s_cbranch_vccz L_poll_done_8
  s_mov_b64 exec, vcc
  s_sub_u32 s70, s70, 1
  s_cmp_eq_u32 s70, 0
  s_cbranch_scc1 L_poll_done_8
  s_sleep 8
  s_branch L_poll_7
L_poll_done_8:
  s_mov_b64 exec, s[68:69]
  v_mov_b32 v22, v28
  s_nop 1
  v_max_f32_dpp v22, v22, v22 row_ror:8 row_mask:0xf bank_mask:0xf
  s_nop 1
  v_max_f32_dpp v22, v22, v22 row_ror:4 row_mask:0xf bank_mask:0xf
  s_nop 1
  v_max_f32_dpp v22, v22, v22 row_ror:2 row_mask:0xf bank_mask:0xf
  s_nop 1
  v_max_f32_dpp v22, v22, v22 row_ror:1 row_mask:0xf bank_mask:0xf
  v_mov_b32 v23, v22
  s_nop 1
  v_permlane16_swap_b32 v22, v23
  v_max_f32 v22, v22, v23
  v_sub_f32 v20, v28, v22
  v_mul_f32 v20, s51, v20
  v_exp_f32 v20, v20
  s_nop 0
  v_mul_f32 v20, v20, v30
  s_nop 1
  v_add_f32_dpp v20, v20, v20 row_ror:8 row_mask:0xf bank_mask:0xf
  s_nop 1
  v_add_f32_dpp v20, v20, v20 row_ror:4 row_mask:0xf bank_mask:0xf
  s_nop 1
  v_add_f32_dpp v20, v20, v20 row_ror:2 row_mask:0xf bank_mask:0xf
  s_nop 1
  v_add_f32_dpp v20, v20, v20 row_ror:1 row_mask:0xf bank_mask:0xf
  v_mov_b32 v23, v20
  s_nop 1
  v_permlane16_swap_b32 v20, v23
  v_add_f32 v20, v20, v23
  v_mov_b32 v16, 1.0
  v_rcp_f32 v21, v20
  s_nop 0
  v_mul_f32 v23, v16, v21
  v_fma_f32 v24, -v23, v20, v16
  v_fma_f32 v23, v24, v21, v23
  s_waitcnt lgkmcnt(0)
  v_sub_f32 v192, v192, v22
  v_sub_f32 v193, v193, v22
  v_sub_f32 v194, v194, v22
  v_sub_f32 v195, v195, v22
  v_mul_f32 v192, s51, v192
  v_mul_f32 v193, s51, v193
  v_mul_f32 v194, s51, v194
  v_mul_f32 v195, s51, v195
  v_exp_f32 v192, v192
  v_exp_f32 v193, v193
  v_exp_f32 v194, v194
  v_exp_f32 v195, v195
  v_mul_f32 v192, v192, v23
  v_mul_f32 v193, v193, v23
  v_mul_f32 v194, v194, v23
  v_mul_f32 v195, v195, v23
  v_cvt_pk_bf16_f32 v192, 0, v192
  v_cvt_pk_bf16_f32 v193, 0, v193
  v_cvt_pk_bf16_f32 v194, 0, v194
  v_cvt_pk_bf16_f32 v195, 0, v195
  ds_write_b128 v10, v[192:195] offset:0
  v_sub_f32 v196, v196, v22
  v_sub_f32 v197, v197, v22
  v_sub_f32 v198, v198, v22
  v_sub_f32 v199, v199, v22
  v_mul_f32 v196, s51, v196
  v_mul_f32 v197, s51, v197
  v_mul_f32 v198, s51, v198
  v_mul_f32 v199, s51, v199
  v_exp_f32 v196, v196
  v_exp_f32 v197, v197
  v_exp_f32 v198, v198
  v_exp_f32 v199, v199
  v_mul_f32 v196, v196, v23
  v_mul_f32 v197, v197, v23
  v_mul_f32 v198, v198, v23
  v_mul_f32 v199, v199, v23
  v_cvt_pk_bf16_f32 v196, 0, v196
  v_cvt_pk_bf16_f32 v197, 0, v197
  v_cvt_pk_bf16_f32 v198, 0, v198
  v_cvt_pk_bf16_f32 v199, 0, v199
  ds_write_b128 v10, v[196:199] offset:1024
  v_sub_f32 v200, v200, v22
  v_sub_f32 v201, v201, v22
  v_sub_f32 v202, v202, v22
  v_sub_f32 v203, v203, v22
  v_mul_f32 v200, s51, v200
  v_mul_f32 v201, s51, v201
  v_mul_f32 v202, s51, v202
  v_mul_f32 v203, s51, v203
  v_exp_f32 v200, v200
  v_exp_f32 v201, v201
  v_exp_f32 v202, v202
  v_exp_f32 v203, v203
  v_mul_f32 v200, v200, v23
  v_mul_f32 v201, v201, v23
  v_mul_f32 v202, v202, v23
  v_mul_f32 v203, v203, v23
  v_cvt_pk_bf16_f32 v200, 0, v200
  v_cvt_pk_bf16_f32 v201, 0, v201
  v_cvt_pk_bf16_f32 v202, 0, v202
  v_cvt_pk_bf16_f32 v203, 0, v203
  ds_write_b128 v10, v[200:203] offset:2048
  v_sub_f32 v204, v204, v22
  v_sub_f32 v205, v205, v22
  v_sub_f32 v206, v206, v22
  v_sub_f32 v207, v207, v22
  v_mul_f32 v204, s51, v204
  v_mul_f32 v205, s51, v205
  v_mul_f32 v206, s51, v206
  v_mul_f32 v207, s51, v207
  v_exp_f32 v204, v204
  v_exp_f32 v205, v205
  v_exp_f32 v206, v206
  v_exp_f32 v207, v207
  v_mul_f32 v204, v204, v23
  v_mul_f32 v205, v205, v23
  v_mul_f32 v206, v206, v23
  v_mul_f32 v207, v207, v23
  v_cvt_pk_bf16_f32 v204, 0, v204
  v_cvt_pk_bf16_f32 v205, 0, v205
  v_cvt_pk_bf16_f32 v206, 0, v206
  v_cvt_pk_bf16_f32 v207, 0, v207
  ds_write_b128 v10, v[204:207] offset:3072
  v_sub_f32 v208, v208, v22
  v_sub_f32 v209, v209, v22
  v_sub_f32 v210, v210, v22
  v_sub_f32 v211, v211, v22
  v_mul_f32 v208, s51, v208
  v_mul_f32 v209, s51, v209
  v_mul_f32 v210, s51, v210
  v_mul_f32 v211, s51, v211
  v_exp_f32 v208, v208
  v_exp_f32 v209, v209
  v_exp_f32 v210, v210
  v_exp_f32 v211, v211
  v_mul_f32 v208, v208, v23
  v_mul_f32 v209, v209, v23
  v_mul_f32 v210, v210, v23
  v_mul_f32 v211, v211, v23
  v_cvt_pk_bf16_f32 v208, 0, v208
  v_cvt_pk_bf16_f32 v209, 0, v209
  v_cvt_pk_bf16_f32 v210, 0, v210
  v_cvt_pk_bf16_f32 v211, 0, v211
  ds_write_b128 v10, v[208:211] offset:4096
  v_sub_f32 v212, v212, v22
  v_sub_f32 v213, v213, v22
  v_sub_f32 v214, v214, v22
  v_sub_f32 v215, v215, v22
  v_mul_f32 v212, s51, v212
  v_mul_f32 v213, s51, v213
  v_mul_f32 v214, s51, v214
  v_mul_f32 v215, s51, v215
  v_exp_f32 v212, v212
  v_exp_f32 v213, v213
  v_exp_f32 v214, v214
  v_exp_f32 v215, v215
  v_mul_f32 v212, v212, v23
  v_mul_f32 v213, v213, v23
  v_mul_f32 v214, v214, v23
  v_mul_f32 v215, v215, v23
  v_cvt_pk_bf16_f32 v212, 0, v212
  v_cvt_pk_bf16_f32 v213, 0, v213
  v_cvt_pk_bf16_f32 v214, 0, v214
  v_cvt_pk_bf16_f32 v215, 0, v215
  ds_write_b128 v10, v[212:215] offset:5120
  v_sub_f32 v216, v216, v22
  v_sub_f32 v217, v217, v22
  v_sub_f32 v218, v218, v22
  v_sub_f32 v219, v219, v22
  v_mul_f32 v216, s51, v216
  v_mul_f32 v217, s51, v217
  v_mul_f32 v218, s51, v218
  v_mul_f32 v219, s51, v219
  v_exp_f32 v216, v216
  v_exp_f32 v217, v217
  v_exp_f32 v218, v218
  v_exp_f32 v219, v219
  v_mul_f32 v216, v216, v23
  v_mul_f32 v217, v217, v23
  v_mul_f32 v218, v218, v23
  v_mul_f32 v219, v219, v23
  v_cvt_pk_bf16_f32 v216, 0, v216
  v_cvt_pk_bf16_f32 v217, 0, v217
  v_cvt_pk_bf16_f32 v218, 0, v218
  v_cvt_pk_bf16_f32 v219, 0, v219
  ds_write_b128 v10, v[216:219] offset:6144
  v_mov_b32 v32, v220
  v_mov_b32 v33, v221
  v_mov_b32 v34, v222
  v_mov_b32 v35, v223
  v_sub_f32 v32, v32, v22
  v_sub_f32 v33, v33, v22
  v_sub_f32 v34, v34, v22
  v_sub_f32 v35, v35, v22
  v_mul_f32 v32, s51, v32
  v_mul_f32 v33, s51, v33
  v_mul_f32 v34, s51, v34
  v_mul_f32 v35, s51, v35
  v_exp_f32 v32, v32
  v_exp_f32 v33, v33
  v_exp_f32 v34, v34
  v_exp_f32 v35, v35
  v_mul_f32 v32, v32, v23
  v_mul_f32 v33, v33, v23
  v_mul_f32 v34, v34, v23
  v_mul_f32 v35, v35, v23
  v_cvt_pk_bf16_f32 v32, 0, v32
  v_cvt_pk_bf16_f32 v33, 0, v33
  v_cvt_pk_bf16_f32 v34, 0, v34
  v_cvt_pk_bf16_f32 v35, 0, v35
  s_mov_b64 exec, 0xffffffff
  ds_write_b128 v10, v[32:35] offset:7168
  s_mov_b64 exec, -1
  s_waitcnt lgkmcnt(0)
  s_barrier
  v_lshrrev_b32 v11, 3, v0
  v_lshlrev_b32 v11, 2, v11
  ds_read_b32 v24, v11 offset:12256
  ds_read_b32 v25, v11 offset:12288
  ds_read_b32 v26, v11 offset:12320
  ds_read_b32 v27, v11 offset:12352
  ds_read_b32 v28, v11 offset:12384
  s_lshl_b32 s53, s4, 17
  s_add_u32 s53, s53, 2097152
  s_lshl_b32 s54, s6, 6
  s_add_u32 s54, s54, s53
  v_and_b32 v12, 6, v0
  v_lshlrev_b32 v12, 3, v12
  v_add_u32 v12, s54, v12
  s_mov_b32 s62, 0x55555555
  s_mov_b32 s63, 0x55555555
  s_waitcnt lgkmcnt(0)
  s_cmp_le_u32 s52, 56
  s_cbranch_scc1 L_exp_done
  v_lshrrev_b32 v16, 16, v220
  v_or_b32 v16, v16, v221
  v_lshrrev_b32 v17, 16, v222
  v_or_b32 v17, v17, v223
  v_subrev_u32 v13, s59, v24
  v_lshrrev_b32 v13, 7, v13
  v_add_u32 v13, v13, v12
  v_mov_b32_dpp v18, v16 quad_perm:[1,1,3,3] row_mask:0xf bank_mask:0xf
  v_mov_b32_dpp v19, v17 quad_perm:[1,1,3,3] row_mask:0xf bank_mask:0xf
  v_cmp_gt_u32 vcc, -2, v24
  s_mov_b32 s60, 0x0
  s_mov_b32 s61, 0xffffffff
  s_and_b64 vcc, vcc, s[60:61]
  s_and_b64 exec, vcc, s[62:63]
  s_cbranch_execz L_expz_9
  global_store_dwordx4 v13, v[16:19], s[42:43] sc1
  s_nop 1
L_expz_9:
  s_mov_b64 exec, -1
  v_sub_f32 v220, v220, v22
  v_sub_f32 v221, v221, v22
  v_sub_f32 v222, v222, v22
  v_sub_f32 v223, v223, v22
  v_mul_f32 v220, s51, v220
  v_mul_f32 v221, s51, v221
  v_mul_f32 v222, s51, v222
  v_mul_f32 v223, s51, v223
  v_exp_f32 v220, v220
  v_exp_f32 v221, v221
  v_exp_f32 v222, v222
  v_exp_f32 v223, v223
  v_mul_f32 v220, v220, v23
  v_mul_f32 v221, v221, v23
  v_mul_f32 v222, v222, v23
  v_mul_f32 v223, v223, v23
  v_cvt_pk_bf16_f32 v220, 0, v220
  v_cvt_pk_bf16_f32 v221, 0, v221
  v_cvt_pk_bf16_f32 v222, 0, v222
  v_cvt_pk_bf16_f32 v223, 0, v223
  ds_write_b128 v10, v[220:223] offset:7168
  s_nop 0
  s_cmp_le_u32 s52, 64
  s_cbranch_scc1 L_exp_done
  v_lshrrev_b32 v16, 16, v224
  v_or_b32 v16, v16, v225
  v_lshrrev_b32 v17, 16, v226
  v_or_b32 v17, v17, v227
  v_subrev_u32 v13, s59, v25
  v_lshrrev_b32 v13, 7, v13
  v_add_u32 v13, v13, v12
  v_mov_b32_dpp v18, v16 quad_perm:[1,1,3,3] row_mask:0xf bank_mask:0xf
  v_mov_b32_dpp v19, v17 quad_perm:[1,1,3,3] row_mask:0xf bank_mask:0xf
  v_cmp_gt_u32 vcc, -2, v25
  s_and_b64 exec, vcc, s[62:63]
  s_cbranch_execz L_expz_10
  global_store_dwordx4 v13, v[16:19], s[42:43] sc1
  s_nop 1
L_expz_10:
  s_mov_b64 exec, -1
  v_sub_f32 v224, v224, v22
  v_sub_f32 v225, v225, v22
  v_sub_f32 v226, v226, v22
  v_sub_f32 v227, v227, v22
  v_mul_f32 v224, s51, v224
  v_mul_f32 v225, s51, v225
  v_mul_f32 v226, s51, v226
  v_mul_f32 v227, s51, v227
  v_exp_f32 v224, v224
  v_exp_f32 v225, v225
  v_exp_f32 v226, v226
  v_exp_f32 v227, v227
  v_mul_f32 v224, v224, v23
  v_mul_f32 v225, v225, v23
  v_mul_f32 v226, v226, v23
  v_mul_f32 v227, v227, v23
  v_cvt_pk_bf16_f32 v224, 0, v224
  v_cvt_pk_bf16_f32 v225, 0, v225
  v_cvt_pk_bf16_f32 v226, 0, v226
  v_cvt_pk_bf16_f32 v227, 0, v227
  ds_write_b128 v10, v[224:227] offset:8192
  s_nop 0
  s_cmp_le_u32 s52, 72
  s_cbranch_scc1 L_exp_done
  v_lshrrev_b32 v16, 16, v228
  v_or_b32 v16, v16, v229
  v_lshrrev_b32 v17, 16, v230
  v_or_b32 v17, v17, v231
  v_subrev_u32 v13, s59, v26
  v_lshrrev_b32 v13, 7, v13
  v_add_u32 v13, v13, v12
  v_mov_b32_dpp v18, v16 quad_perm:[1,1,3,3] row_mask:0xf bank_mask:0xf
  v_mov_b32_dpp v19, v17 quad_perm:[1,1,3,3] row_mask:0xf bank_mask:0xf
  v_cmp_gt_u32 vcc, -2, v26
  s_and_b64 exec, vcc, s[62:63]
  s_cbranch_execz L_expz_11
  global_store_dwordx4 v13, v[16:19], s[42:43] sc1
  s_nop 1
L_expz_11:
  s_mov_b64 exec, -1
  v_sub_f32 v228, v228, v22
  v_sub_f32 v229, v229, v22
  v_sub_f32 v230, v230, v22
  v_sub_f32 v231, v231, v22
  v_mul_f32 v228, s51, v228
  v_mul_f32 v229, s51, v229
  v_mul_f32 v230, s51, v230
  v_mul_f32 v231, s51, v231
  v_exp_f32 v228, v228
  v_exp_f32 v229, v229
  v_exp_f32 v230, v230
  v_exp_f32 v231, v231
  v_mul_f32 v228, v228, v23
  v_mul_f32 v229, v229, v23
  v_mul_f32 v230, v230, v23
  v_mul_f32 v231, v231, v23
  v_cvt_pk_bf16_f32 v228, 0, v228
  v_cvt_pk_bf16_f32 v229, 0, v229
  v_cvt_pk_bf16_f32 v230, 0, v230
  v_cvt_pk_bf16_f32 v231, 0, v231
  ds_write_b128 v10, v[228:231] offset:9216
  s_nop 0
  s_cmp_le_u32 s52, 80
  s_cbranch_scc1 L_exp_done
  v_lshrrev_b32 v16, 16, v232
  v_or_b32 v16, v16, v233
  v_lshrrev_b32 v17, 16, v234
  v_or_b32 v17, v17, v235
  v_subrev_u32 v13, s59, v27
  v_lshrrev_b32 v13, 7, v13
  v_add_u32 v13, v13, v12
  v_mov_b32_dpp v18, v16 quad_perm:[1,1,3,3] row_mask:0xf bank_mask:0xf
  v_mov_b32_dpp v19, v17 quad_perm:[1,1,3,3] row_mask:0xf bank_mask:0xf
  v_cmp_gt_u32 vcc, -2, v27
  s_and_b64 exec, vcc, s[62:63]
  s_cbranch_execz L_expz_12
  global_store_dwordx4 v13, v[16:19], s[42:43] sc1
  s_nop 1
L_expz_12:
  s_mov_b64 exec, -1
  v_sub_f32 v232, v232, v22
  v_sub_f32 v233, v233, v22
  v_sub_f32 v234, v234, v22
  v_sub_f32 v235, v235, v22
  v_mul_f32 v232, s51, v232
  v_mul_f32 v233, s51, v233
  v_mul_f32 v234, s51, v234
  v_mul_f32 v235, s51, v235
  v_exp_f32 v232, v232
  v_exp_f32 v233, v233
  v_exp_f32 v234, v234
  v_exp_f32 v235, v235
  v_mul_f32 v232, v232, v23
  v_mul_f32 v233, v233, v23
  v_mul_f32 v234, v234, v23
  v_mul_f32 v235, v235, v23
  v_cvt_pk_bf16_f32 v232, 0, v232
  v_cvt_pk_bf16_f32 v233, 0, v233
  v_cvt_pk_bf16_f32 v234, 0, v234
  v_cvt_pk_bf16_f32 v235, 0, v235
  ds_write_b128 v10, v[232:235] offset:10240
  s_nop 0
  s_cmp_le_u32 s52, 88
  s_cbranch_scc1 L_exp_done
  v_lshrrev_b32 v16, 16, v236
  v_or_b32 v16, v16, v237
  v_lshrrev_b32 v17, 16, v238
  v_or_b32 v17, v17, v239
  v_subrev_u32 v13, s59, v28
  v_lshrrev_b32 v13, 7, v13
  v_add_u32 v13, v13, v12
  v_mov_b32_dpp v18, v16 quad_perm:[1,1,3,3] row_mask:0xf bank_mask:0xf
  v_mov_b32_dpp v19, v17 quad_perm:[1,1,3,3] row_mask:0xf bank_mask:0xf
  v_cmp_gt_u32 vcc, -2, v28
  s_and_b64 exec, vcc, s[62:63]
  s_cbranch_execz L_expz_13
  global_store_dwordx4 v13, v[16:19], s[42:43] sc1
  s_nop 1
L_expz_13:
  s_mov_b64 exec, -1
  v_sub_f32 v236, v236, v22
  v_sub_f32 v237, v237, v22
  v_sub_f32 v238, v238, v22
  v_sub_f32 v239, v239, v22
  v_mul_f32 v236, s51, v236
  v_mul_f32 v237, s51, v237
  v_mul_f32 v238, s51, v238
  v_mul_f32 v239, s51, v239
  v_exp_f32 v236, v236
  v_exp_f32 v237, v237
  v_exp_f32 v238, v238
  v_exp_f32 v239, v239
  v_mul_f32 v236, v236, v23
  v_mul_f32 v237, v237, v23
  v_mul_f32 v238, v238, v23
  v_mul_f32 v239, v239, v23
  v_cvt_pk_bf16_f32 v236, 0, v236
  v_cvt_pk_bf16_f32 v237, 0, v237
  v_cvt_pk_bf16_f32 v238, 0, v238
  v_cvt_pk_bf16_f32 v239, 0, v239
  ds_write_b128 v10, v[236:239] offset:11264
  s_nop 0
L_exp_done:
  s_waitcnt vmcnt(0)
  v_mov_b32 v11, 1
  v_mov_b32 v12, 0
  s_mov_b64 exec, 1
  ds_add_rtn_u32 v13, v12, v11 offset:8
  s_mov_b64 exec, -1
  s_waitcnt lgkmcnt(0)
  v_readfirstlane_b32 s50, v13
  s_nop 0
  s_cmp_lg_u32 s50, 3
  s_cbranch_scc1 L_noxf
  s_lshl_b32 s50, s2, 4
  s_add_u32 s50, s50, 40960
  v_mov_b32 v13, s50
  v_mov_b32 v16, v49
  v_mov_b32 v17, v49
  v_mov_b32 v18, v49
  v_mov_b32 v19, v49
  s_mov_b64 exec, 1
  global_store_dwordx4 v13, v[16:19], s[42:43] sc1
  s_nop 1
  s_mov_b64 exec, -1
L_noxf:
  s_cmp_lg_u32 s3, 4
  s_cbranch_scc1 L_noschedv
  s_lshl_b32 s50, s4, 7
  s_add_u32 s50, s50, 40960
  v_and_b32 v13, 7, v0
  v_lshlrev_b32 v13, 4, v13
  v_add_u32 v13, s50, v13
  s_mov_b64 s[68:69], exec
  s_mov_b32 s70, 131072
L_poll_14:
  global_load_dword v16, v13, s[42:43] sc1
  s_waitcnt vmcnt(0)
  v_cmp_ne_u32 vcc, v16, v49
  s_cbranch_vccz L_poll_done_15
  s_mov_b64 exec, vcc
  s_sub_u32 s70, s70, 1
  s_cmp_eq_u32 s70, 0
  s_cbranch_scc1 L_poll_done_15
  s_sleep 64
  s_branch L_poll_14
L_poll_done_15:
  s_mov_b64 exec, s[68:69]
  v_mov_b32 v12, 0
  s_mov_b32 s70, 2097152
L_xw_spin:
  ds_read_b32 v13, v12 offset:8
  s_waitcnt lgkmcnt(0)
  v_readfirstlane_b32 s50, v13
  s_sub_u32 s70, s70, 1
  s_cmp_eq_u32 s70, 0
  s_cbranch_scc1 L_xw_done
  s_cmp_ge_u32 s50, 4
  s_cbranch_scc1 L_xw_done
  s_sleep 8
  s_branch L_xw_spin
L_xw_done:
  s_lshl_b32 s50, s4, 8
  s_add_u32 s50, s50, 32896
  v_lshl_add_u32 v16, v0, 2, s50
  s_mov_b32 s66, s5
  s_mov_b32 s67, 0
  s_mov_b32 s88, 2
  s_mov_b32 s90, 0
  s_mov_b32 s52, 60
  s_mov_b32 s56, -1
  s_mov_b32 s62, 0
  v_mov_b32 v17, 0
  v_add_u32 v24, s53, v6
  v_bfe_u32 v25, v0, 2, 2
  v_lshlrev_b32 v25, 14, v25
  v_lshrrev_b32 v26, 4, v0
  v_lshl_add_u32 v25, v26, 7, v25
  v_lshl_add_u32 v25, v2, 5, v25
  v_add_u32 v25, 13312, v25
  s_mov_b32 s70, 2097152
L_sv_top:
  ds_read_b128 v[32:35], v17 offset:112
  s_waitcnt lgkmcnt(0)
  v_max3_u32 v32, v32, v33, v34
  v_max_u32 v32, v32, v35
  s_nop 0
  v_readfirstlane_b32 s64, v32
  s_sub_u32 s70, s70, 1
  s_cmp_eq_u32 s70, 0
  s_cbranch_scc1 L_sv_done
  s_cmp_eq_u32 s67, 0
  s_cselect_b32 s65, 5, 5
  s_add_u32 s64, s64, s65
  s_mov_b32 s65, 0
  s_cmp_lg_u32 s62, 0
  s_cbranch_scc1 L_sv_noclaim
  s_cmp_lt_u32 s64, s52
  s_cbranch_scc1 L_sv_noclaim
  s_cmp_ge_u32 s52, 94
  s_cbranch_scc1 L_sv_full
  s_mov_b32 s65, 1
  s_cmp_lg_u32 s90, 0
  s_cbranch_scc1 L_ci_16
  v_mov_b32 v18, s88
  s_lshl_b32 s60, 1, s66
  s_mov_b32 s61, 0
  s_mov_b64 exec, s[60:61]
  global_atomic_add v19, v16, v18, s[42:43] sc0 sc1
  s_branch L_ci_17
L_ci_16:
  s_mov_b64 exec, 0xff
  global_load_dword v15, v16, s[42:43] sc1
L_ci_17:
  s_mov_b64 exec, -1
  s_branch L_sv_pend
L_sv_full:
  s_mov_b32 s62, 1
L_sv_noclaim:
  s_cmp_lg_u32 s56, -1
  s_cbranch_scc1 L_sv_pend
  s_cmp_lg_u32 s62, 0
  s_cbranch_scc1 L_sv_done
  s_sub_u32 s64, s52, s64
  s_cmp_gt_u32 s64, 4
  s_cbranch_scc1 L_sv_long
  s_sleep 2
  s_branch L_sv_top
L_sv_long:
  s_sleep 32
  s_branch L_sv_top
L_sv_pend:
  s_cmp_eq_u32 s56, -1
  s_cbranch_scc1 L_sv_nofetch
  s_lshl_b32 s60, s56, 8
  v_add_u32 v26, s60, v24
  s_cmp_eq_u32 s89, 2
  s_cselect_b32 s60, -1, 0xffff
  s_mov_b32 s61, 0
  s_mov_b64 exec, s[60:61]
  global_load_dwordx4 v[28:31], v26, s[42:43] sc1
  s_lshl_b32 s60, s55, 7
  v_add_u32 v26, s60, v25
  s_waitcnt vmcnt(0)
  v_lshlrev_b32 v32, 16, v28
  v_and_b32 v33, 0xffff0000, v28
  v_lshlrev_b32 v34, 16, v29
  v_and_b32 v35, 0xffff0000, v29
  v_lshlrev_b32 v36, 16, v30
  v_and_b32 v37, 0xffff0000, v30
  v_lshlrev_b32 v38, 16, v31
  v_and_b32 v39, 0xffff0000, v31
  v_sub_f32 v32, v32, v22
  v_sub_f32 v33, v33, v22
  v_sub_f32 v34, v34, v22
  v_sub_f32 v35, v35, v22
  v_sub_f32 v36, v36, v22
  v_sub_f32 v37, v37, v22
  v_sub_f32 v38, v38, v22
  v_sub_f32 v39, v39, v22
  v_mul_f32 v32, s51, v32
  v_mul_f32 v33, s51, v33
  v_mul_f32 v34, s51, v34
  v_mul_f32 v35, s51, v35
  v_mul_f32 v36, s51, v36
  v_mul_f32 v37, s51, v37
  v_mul_f32 v38, s51, v38
  v_mul_f32 v39, s51, v39
  v_exp_f32 v32, v32
  v_exp_f32 v33, v33
  v_exp_f32 v34, v34
  v_exp_f32 v35, v35
  v_exp_f32 v36, v36
  v_exp_f32 v37, v37
  v_exp_f32 v38, v38
  v_exp_f32 v39, v39
  v_mul_f32 v32, v32, v23
  v_mul_f32 v33, v33, v23
  v_mul_f32 v34, v34, v23
  v_mul_f32 v35, v35, v23
  v_mul_f32 v36, v36, v23
  v_mul_f32 v37, v37, v23
  v_mul_f32 v38, v38, v23
  v_mul_f32 v39, v39, v23
  v_cvt_pk_bf16_f32 v32, 0, v32
  v_cvt_pk_bf16_f32 v33, 0, v33
  v_cvt_pk_bf16_f32 v34, 0, v34
  v_cvt_pk_bf16_f32 v35, 0, v35
  v_cvt_pk_bf16_f32 v36, 0, v36
  v_cvt_pk_bf16_f32 v37, 0, v37
  v_cvt_pk_bf16_f32 v38, 0, v38
  v_cvt_pk_bf16_f32 v39, 0, v39
  ds_write_b128 v26, v[32:35]
  ds_write_b128 v26, v[36:39] offset:16
  v_lshrrev_b32 v26, 4, v0
  v_add_u32 v27, s56, v26
  v_lshlrev_b32 v27, 15, v27
  v_add_u32 v27, s59, v27
  v_add_u32 v26, s55, v26
  v_lshlrev_b32 v26, 2, v26
  ds_write_b32 v26, v27 offset:12544
  s_mov_b64 exec, -1
  s_mov_b32 s56, -1
L_sv_nofetch:
  s_cmp_eq_u32 s65, 0
  s_cbranch_scc1 L_sv_top
  s_waitcnt vmcnt(0)
  s_cmp_lg_u32 s90, 0
  s_cbranch_scc1 L_sv_got_snap
  v_readlane_b32 s63, v19, s66
  s_lshl_b32 s61, 1, s66
  s_cmp_lt_u32 s63, 4
  s_cbranch_scc0 L_sv_got_miss
  s_sub_u32 s54, 4, s63
  s_min_u32 s54, s54, s88
  s_add_u32 s60, s63, s54
  s_cmp_lt_u32 s60, 2
  s_cselect_b32 s88, s88, 1
  s_cmp_lg_u32 s66, s5
  s_cselect_b32 s90, 1, 0
  s_cmp_ge_u32 s60, 4
  s_cselect_b32 s90, 1, s90
  s_cselect_b32 s61, s61, 0
  s_or_b32 s67, s67, s61
  s_lshl_b32 s60, s66, 6
  s_add_u32 s63, s63, s60
  s_add_u32 s63, s63, 60
  s_branch L_sv_got
L_sv_got_miss:
  s_or_b32 s67, s67, s61
  s_mov_b32 s88, 1
  s_mov_b32 s90, 1
  s_branch L_sv_top
L_sv_got_snap:
  v_cmp_gt_u32 vcc, 4, v15
  s_mov_b32 s90, 0
  s_mov_b32 s88, 1
  s_andn2_b32 s60, vcc_lo, s67
  s_and_b32 s60, s60, 0xff
  s_cbranch_scc0 L_sv_done
  s_lshl_b32 s61, s60, 8
  s_or_b32 s60, s60, s61
  s_lshr_b32 s60, s60, s5
  s_ff1_i32_b32 s60, s60
  s_add_u32 s66, s60, s5
  s_and_b32 s66, s66, 7
  s_branch L_sv_top
L_sv_got:
  s_mov_b32 s56, s63
  s_mov_b32 s55, s52
  s_add_u32 s52, s52, s54
  s_mov_b32 s89, s54
  v_and_b32 v26, 1, v0
  v_add_u32 v27, s56, v26
  v_lshlrev_b32 v27, 15, v27
  v_add_u32 v27, s59, v27
  v_add_u32 v26, s55, v26
  v_lshlrev_b32 v26, 2, v26
  ds_read_b32 v28, v26 offset:12032
  s_lshl_b32 s60, 1, s54
  s_sub_u32 s60, s60, 1
  s_mov_b32 s61, 0
  s_waitcnt lgkmcnt(0)
  s_mov_b64 exec, s[60:61]
  v_cmp_ne_u32 vcc, v28, v27
  s_cbranch_vccnz L_sv_other
  ds_write_b32 v26, v27 offset:12544
  s_mov_b32 s56, -1
L_sv_other:
  s_mov_b64 exec, -1
  s_branch L_sv_top
L_sv_done:
  s_lshl_b32 s55, s52, 2
  v_mov_b32 v26, s55
  v_mov_b32 v27, -2
  ds_write_b32 v26, v27 offset:12544
  v_mov_b32 v27, s52
  ds_write_b32 v17, v27 offset:128
L_noschedv:
  s_cmp_lg_u32 s3, 7
  s_cbranch_scc1 L_noticket
  v_mov_b32 v18, 1
  v_mov_b32 v17, 0
  s_mov_b32 s70, 2097152
L_tk_wait:
  ds_read_b128 v[32:35], v17 offset:112
  ds_read_b32 v36, v17 offset:128
  s_waitcnt lgkmcnt(0)
  v_max3_u32 v32, v32, v33, v34
  v_max_u32 v32, v32, v35
  v_readfirstlane_b32 s51, v36
  v_readfirstlane_b32 s50, v32
  s_sub_u32 s70, s70, 1
  s_cmp_eq_u32 s70, 0
  s_cbranch_scc1 L_tk_go
  s_cmp_eq_u32 s51, 0
  s_cbranch_scc1 L_tk_long
  s_add_u32 s50, s50, 1
  s_cmp_ge_u32 s50, s51
  s_cbranch_scc1 L_tk_go
  s_sleep 2
  s_branch L_tk_wait
L_tk_long:
  s_sleep 24
  s_branch L_tk_wait
L_tk_go:
  s_mov_b64 exec, 1
  global_atomic_add v19, v17, v18, s[40:41] sc0 sc1
  s_waitcnt vmcnt(0)
  ds_write_b32 v17, v19 offset:132
  s_mov_b64 exec, -1
  v_readfirstlane_b32 s57, v19
  s_waitcnt lgkmcnt(0)
L_noticket:
  v_lshlrev_b32 v216, 16, v56
  v_and_b32 v217, 0xffff0000, v56
  v_lshlrev_b32 v218, 16, v57
  v_and_b32 v219, 0xffff0000, v57
  v_lshlrev_b32 v220, 16, v58
  v_and_b32 v221, 0xffff0000, v58
  v_lshlrev_b32 v222, 16, v59
  v_and_b32 v223, 0xffff0000, v59
  s_lshl_b32 s50, s4, 12
  s_add_u32 s50, s50, s7
  s_add_u32 s50, s50, 65536
  v_lshrrev_b32 v10, 3, v0
  v_lshlrev_b32 v13, 4, v10
  v_lshlrev_b32 v10, 9, v10
  v_and_b32 v11, 7, v0
  v_lshl_add_u32 v10, v11, 4, v10
  v_add_u32 v10, s50, v10
  v_add_u32 v15, s7, v48
  v_add_u32 v9, s7, v13
  v_lshrrev_b32 v14, 4, v0
  v_lshlrev_b32 v14, 3, v14
  v_lshl_add_u32 v14, v11, 5, v14
  s_lshl_b32 s52, s6, 8
  v_add_u32 v14, s52, v14
  v_and_b32 v8, 15, v0
  v_lshlrev_b32 v8, 4, v8
  v_lshrrev_b32 v7, 4, v0
  v_lshl_add_u32 v8, v7, 16, v8
  s_lshl_b32 s51, s2, 8
  s_add_u32 s51, s51, 196608
  v_add_u32 v8, s51, v8
  v_add_u32 v7, 0x40000, v8
  v_and_b32 v5, 15, v0
  v_lshlrev_b32 v5, 4, v5
  v_mov_b32 v24, 0
  v_mov_b32 v25, 0
  v_mov_b32 v26, 0
  v_mov_b32 v27, 0
  v_mov_b32 v28, 0
  v_mov_b32 v29, 0
  v_mov_b32 v30, 0
  v_mov_b32 v31, 0
  s_barrier
  v_mov_b32 v12, 0
  ds_read_b32 v50, v12 offset:132
  s_cmp_lg_u32 s3, 7
  s_cbranch_scc1 L_tk_end
  s_cmp_ge_u32 s57, 56
  s_cbranch_scc1 L_tk_end
  v_lshlrev_b32 v228, 5, v0
  v_add_u32 v228, 8192, v228
  v_add_u32 v229, 4096, v228
  v_and_b32 v230, 15, v0
  v_lshlrev_b32 v231, 3, v230
  s_and_b32 s50, s57, 15
  s_lshl_b32 s50, s50, 7
  s_add_u32 s50, s50, 14336
  v_add_u32 v231, s50, v231
  v_add_u32 v51, 40960, v6
  s_mov_b64 s[68:69], exec
  s_mov_b32 s70, 131072
L_poll_18:
  global_load_dwordx4 v[144:147], v228, s[42:43] sc1
  global_load_dwordx4 v[148:151], v228, s[42:43] offset:16 sc1
  global_load_dwordx4 v[152:155], v228, s[42:43] offset:2048 sc1
  global_load_dwordx4 v[156:159], v228, s[42:43] offset:2064 sc1
  global_load_dwordx4 v[160:163], v229, s[42:43] sc1
  global_load_dwordx4 v[164:167], v229, s[42:43] offset:16 sc1
  global_load_dwordx2 v[172:173], v231, s[42:43] sc1
  global_load_dword v168, v51, s[42:43] offset:0 sc1
  global_load_dword v169, v51, s[42:43] offset:1024 sc1
  global_load_dword v170, v51, s[42:43] offset:2048 sc1
  global_load_dword v171, v51, s[42:43] offset:3072 sc1
  s_waitcnt vmcnt(0)
  v_cmp_ne_u32 vcc, v173, v49
  v_cmp_ne_u32 s[60:61], v168, v49
  s_or_b64 vcc, vcc, s[60:61]
  v_cmp_ne_u32 s[60:61], v169, v49
  s_or_b64 vcc, vcc, s[60:61]
  v_cmp_ne_u32 s[60:61], v170, v49
  s_or_b64 vcc, vcc, s[60:61]
  v_cmp_ne_u32 s[60:61], v171, v49
  s_or_b64 vcc, vcc, s[60:61]
  v_cmp_ne_u32 s[60:61], v145, v49
  s_or_b64 vcc, vcc, s[60:61]
  v_cmp_ne_u32 s[60:61], v147, v49
  s_or_b64 vcc, vcc, s[60:61]
  v_cmp_ne_u32 s[60:61], v149, v49
  s_or_b64 vcc, vcc, s[60:61]
  v_cmp_ne_u32 s[60:61], v151, v49
  s_or_b64 vcc, vcc, s[60:61]
  v_cmp_ne_u32 s[60:61], v153, v49
  s_or_b64 vcc, vcc, s[60:61]
  v_cmp_ne_u32 s[60:61], v155, v49
  s_or_b64 vcc, vcc, s[60:61]
  v_cmp_ne_u32 s[60:61], v157, v49
  s_or_b64 vcc, vcc, s[60:61]
  v_cmp_ne_u32 s[60:61], v159, v49
  s_or_b64 vcc, vcc, s[60:61]
  v_cmp_ne_u32 s[60:61], v161, v49
  s_or_b64 vcc, vcc, s[60:61]
  v_cmp_ne_u32 s[60:61], v163, v49
  s_or_b64 vcc, vcc, s[60:61]
  v_cmp_ne_u32 s[60:61], v165, v49
  s_or_b64 vcc, vcc, s[60:61]
  v_cmp_ne_u32 s[60:61], v167, v49
  s_or_b64 vcc, vcc, s[60:61]
  s_cbranch_vccz L_poll_done_19
  s_mov_b64 exec, vcc
  s_sub_u32 s70, s70, 1
  s_cmp_eq_u32 s70, 0
  s_cbranch_scc1 L_poll_done_19
  s_sleep 8
  s_branch L_poll_18
L_poll_done_19:
  s_mov_b64 exec, s[68:69]
  v_mov_b32 v145, v146
  v_mov_b32 v146, v148
  v_mov_b32 v147, v150
  ds_write_b128 v6, v[144:147] offset:8704
  v_mov_b32 v153, v154
  v_mov_b32 v154, v156
  v_mov_b32 v155, v158
  ds_write_b128 v6, v[152:155] offset:9728
  v_mov_b32 v161, v162
  v_mov_b32 v162, v164
  v_mov_b32 v163, v166
  ds_write_b128 v6, v[160:163] offset:10752
  v_lshlrev_b32 v230, 2, v230
  ds_write_b32 v230, v172 offset:11776
  v_mov_b32 v51, 1
  s_mov_b64 exec, 1
  ds_add_u32 v12, v51 offset:16
  s_mov_b64 exec, -1
L_tk_end:
  s_mov_b64 s[68:69], exec
  s_mov_b32 s70, 131072
L_poll_20:
  global_load_dwordx4 v[16:19], v10, s[42:43] sc1
  s_waitcnt vmcnt(0)
  v_max3_u32 v20, v16, v17, v18
  v_max_u32 v20, v20, v19
  v_cmp_eq_u32 vcc, -1, v20
  s_cbranch_vccz L_poll_done_21
  s_mov_b64 exec, vcc
  s_sub_u32 s70, s70, 1
  s_cmp_eq_u32 s70, 0
  s_cbranch_scc1 L_poll_done_21
  s_sleep 1
  s_branch L_poll_20
L_poll_done_21:
  s_mov_b64 exec, s[68:69]
  v_permlane32_swap_b32 v16, v18
  v_permlane32_swap_b32 v17, v19
  v_add_f32 v16, v16, v18
  v_add_f32 v17, v17, v19
  s_nop 1
  v_permlane16_swap_b32 v16, v17
  v_add_f32 v16, v16, v17
  s_nop 1
  v_add_f32_dpp v16, v16, v16 row_ror:8 row_mask:0xf bank_mask:0xf
  v_cvt_pk_bf16_f32 v16, 0, v16
  ds_write_b32 v15, v16 offset:7168
  ds_read_b128 v[16:19], v9 offset:7168
  s_waitcnt lgkmcnt(0)
  v_lshrrev_b32 v20, 16, v16
  v_lshrrev_b32 v21, 16, v17
  v_lshrrev_b32 v22, 16, v18
  v_lshrrev_b32 v23, 16, v19
  v_dot2c_f32_bf16 v24, v20, v64
  v_dot2c_f32_bf16 v25, v16, v64
  v_dot2c_f32_bf16 v26, v20, v65
  v_dot2c_f32_bf16 v27, v16, v65
  v_dot2c_f32_bf16 v28, v20, v66
  v_dot2c_f32_bf16 v29, v16, v66
  v_dot2c_f32_bf16 v30, v20, v67
  v_dot2c_f32_bf16 v31, v16, v67
  v_dot2c_f32_bf16 v24, v21, v68
  v_dot2c_f32_bf16 v25, v17, v68
  v_dot2c_f32_bf16 v26, v21, v69
  v_dot2c_f32_bf16 v27, v17, v69
  v_dot2c_f32_bf16 v28, v21, v70
  v_dot2c_f32_bf16 v29, v17, v70
  v_dot2c_f32_bf16 v30, v21, v71
  v_dot2c_f32_bf16 v31, v17, v71
  v_dot2c_f32_bf16 v24, v22, v72
  v_dot2c_f32_bf16 v25, v18, v72
  v_dot2c_f32_bf16 v26, v22, v73
  v_dot2c_f32_bf16 v27, v18, v73
  v_dot2c_f32_bf16 v28, v22, v74
  v_dot2c_f32_bf16 v29, v18, v74
  v_dot2c_f32_bf16 v30, v22, v75
  v_dot2c_f32_bf16 v31, v18, v75
  v_dot2c_f32_bf16 v24, v23, v76
  v_dot2c_f32_bf16 v25, v19, v76
  v_dot2c_f32_bf16 v26, v23, v77
  v_dot2c_f32_bf16 v27, v19, v77
  v_dot2c_f32_bf16 v28, v23, v78
  v_dot2c_f32_bf16 v29, v19, v78
  v_dot2c_f32_bf16 v30, v23, v79
  v_dot2c_f32_bf16 v31, v19, v79
  s_nop 0
  s_nop 1
  v_permlane32_swap_b32 v24, v28
  v_permlane32_swap_b32 v25, v29
  v_permlane32_swap_b32 v26, v30
  v_permlane32_swap_b32 v27, v31
  v_add_f32 v24, v24, v28
  v_add_f32 v25, v25, v29
  v_add_f32 v26, v26, v30
  v_add_f32 v27, v27, v31
  s_nop 0
  v_permlane16_swap_b32 v24, v26
  v_permlane16_swap_b32 v25, v27
  v_add_f32 v24, v24, v26
  v_add_f32 v25, v25, v27
  s_nop 0
  v_add_f32_dpp v24, v24, v24 row_ror:8 row_mask:0xf bank_mask:0xf
  v_add_f32_dpp v25, v25, v25 row_ror:8 row_mask:0xf bank_mask:0xf
  ds_write_b64 v14, v[24:25] offset:7680
  v_mov_b32 v11, 1
  v_mov_b32 v12, 0
  s_mov_b64 exec, 1
  ds_add_rtn_u32 v13, v12, v11 offset:12
  s_mov_b64 exec, -1
  s_waitcnt lgkmcnt(0)
  v_readfirstlane_b32 s50, v13
  s_nop 0
  s_cmp_lg_u32 s50, 3
  s_cbranch_scc1 L_h_noap
  s_mov_b64 exec, 0xffff
  ds_read_b128 v[16:19], v5 offset:7680
  ds_read_b128 v[20:23], v5 offset:7936
  ds_read_b128 v[24:27], v5 offset:8192
  ds_read_b128 v[28:31], v5 offset:8448
  s_waitcnt lgkmcnt(0)
  v_pk_add_f32 v[16:17], v[16:17], v[20:21]
  v_pk_add_f32 v[24:25], v[24:25], v[28:29]
  v_pk_add_f32 v[18:19], v[18:19], v[22:23]
  v_pk_add_f32 v[26:27], v[26:27], v[30:31]
  v_pk_add_f32 v[16:17], v[16:17], v[24:25]
  v_pk_add_f32 v[18:19], v[18:19], v[26:27]
  v_min_u32 v16, -2, v16
  v_min_u32 v17, -2, v17
  v_min_u32 v18, -2, v18
  v_min_u32 v19, -2, v19
  global_store_dwordx4 v8, v[16:19], s[42:43] sc1
  s_nop 1
  s_mov_b64 exec, -1
L_h_noap:
  v_readfirstlane_b32 s57, v50
  s_nop 0
  s_cmp_ge_u32 s57, 56
  s_cbranch_scc1 L_end
  s_movk_i32 s50, 528
  v_mul_lo_u32 v10, v0, s50
  s_lshl_b32 s50, s6, 4
  s_add_u32 s50, s50, 78848
  v_add_u32 v10, s50, v10
  v_add_u32 v11, 33792, v10
  s_lshl_b32 s50, s6, 13
  s_add_u32 s50, s50, 46080
  v_add_u32 v14, s50, v6
  v_mov_b32 v12, 0
  s_mov_b32 s70, 2097152
L_hst_spin:
  ds_read_b32 v13, v12 offset:16
  s_waitcnt lgkmcnt(0)
  v_readfirstlane_b32 s50, v13
  s_sub_u32 s70, s70, 1
  s_cmp_eq_u32 s70, 0
  s_cbranch_scc1 L_hst_done
  s_cmp_ge_u32 s50, 5
  s_cbranch_scc1 L_hst_done
  s_sleep 1
  s_branch L_hst_spin
L_hst_done:
  ds_read_b128 v[80:83], v10 offset:0
  ds_read_b128 v[112:115], v11 offset:0
  ds_read_b128 v[144:147], v14 offset:0
  ds_read_b128 v[84:87], v10 offset:64
  ds_read_b128 v[116:119], v11 offset:64
  ds_read_b128 v[148:151], v14 offset:1024
  ds_read_b128 v[88:91], v10 offset:128
  ds_read_b128 v[120:123], v11 offset:128
  ds_read_b128 v[152:155], v14 offset:2048
  ds_read_b128 v[92:95], v10 offset:192
  ds_read_b128 v[124:127], v11 offset:192
  ds_read_b128 v[156:159], v14 offset:3072
  s_waitcnt lgkmcnt(0)
  ds_read_b128 v[96:99], v10 offset:256
  ds_read_b128 v[128:131], v11 offset:256
  ds_read_b128 v[160:163], v14 offset:4096
  ds_read_b128 v[100:103], v10 offset:320
  ds_read_b128 v[132:135], v11 offset:320
  ds_read_b128 v[164:167], v14 offset:5120
  ds_read_b128 v[104:107], v10 offset:384
  ds_read_b128 v[136:139], v11 offset:384
  ds_read_b128 v[168:171], v14 offset:6144
  ds_read_b128 v[108:111], v10 offset:448
  ds_read_b128 v[140:143], v11 offset:448
  ds_read_b128 v[172:175], v14 offset:7168
  s_waitcnt lgkmcnt(0)
  ds_read_b128 v[16:19], v6 offset:8704
  ds_read_b128 v[20:23], v6 offset:9728
  ds_read_b128 v[24:27], v6 offset:10752
  v_lshrrev_b32 v13, 3, v48
  v_lshlrev_b32 v13, 2, v13
  ds_read_b32 v28, v13 offset:11776
  s_waitcnt lgkmcnt(0)
  v_lshlrev_b32 v192, 16, v16
  v_and_b32 v193, 0xffff0000, v16
  v_lshlrev_b32 v194, 16, v17
  v_and_b32 v195, 0xffff0000, v17
  v_lshlrev_b32 v196, 16, v18
  v_and_b32 v197, 0xffff0000, v18
  v_lshlrev_b32 v198, 16, v19
  v_and_b32 v199, 0xffff0000, v19
  v_lshlrev_b32 v200, 16, v20
  v_and_b32 v201, 0xffff0000, v20
  v_lshlrev_b32 v202, 16, v21
  v_and_b32 v203, 0xffff0000, v21
  v_lshlrev_b32 v204, 16, v22
  v_and_b32 v205, 0xffff0000, v22
  v_lshlrev_b32 v206, 16, v23
  v_and_b32 v207, 0xffff0000, v23
  v_lshlrev_b32 v208, 16, v24
  v_and_b32 v209, 0xffff0000, v24
  v_lshlrev_b32 v210, 16, v25
  v_and_b32 v211, 0xffff0000, v25
  v_lshlrev_b32 v212, 16, v26
  v_and_b32 v213, 0xffff0000, v26
  v_lshlrev_b32 v214, 16, v27
  v_and_b32 v215, 0xffff0000, v27
  v_add_f32 v208, 1.0, v208
  v_add_f32 v209, 1.0, v209
  v_add_f32 v210, 1.0, v210
  v_add_f32 v211, 1.0, v211
  v_add_f32 v212, 1.0, v212
  v_add_f32 v213, 1.0, v213
  v_add_f32 v214, 1.0, v214
  v_add_f32 v215, 1.0, v215
  v_cvt_pk_bf16_f32 v208, 0, v208
  v_cvt_pk_bf16_f32 v209, 0, v209
  v_cvt_pk_bf16_f32 v210, 0, v210
  v_cvt_pk_bf16_f32 v211, 0, v211
  v_cvt_pk_bf16_f32 v212, 0, v212
  v_cvt_pk_bf16_f32 v213, 0, v213
  v_cvt_pk_bf16_f32 v214, 0, v214
  v_cvt_pk_bf16_f32 v215, 0, v215
  v_and_b32 v13, 16, v0
  v_cmp_eq_u32 vcc, 0, v13
  v_lshlrev_b32 v13, 16, v28
  v_and_b32 v14, 0xffff0000, v28
  v_cndmask_b32 v224, v14, v13, vcc
L_gather_ap:
  s_and_b32 s50, s3, 1
  s_lshl_b32 s50, s50, 10
  s_lshr_b32 s51, s3, 1
  s_lshl_b32 s52, s51, 14
  s_add_u32 s52, s52, s50
  s_add_u32 s52, s52, 200704
  v_lshlrev_b32 v10, 4, v0
  v_add_u32 v11, s52, v10
  v_add_u32 v12, 8192, v11
  s_lshl_b32 s51, s51, 11
  s_add_u32 s51, s51, s50
  v_add_u32 v13, s51, v10
  s_mov_b64 s[72:73], -1
  s_mov_b64 s[74:75], -1
  s_mov_b64 s[76:77], -1
  s_mov_b64 s[78:79], -1
  s_mov_b64 s[80:81], -1
  s_mov_b64 s[82:83], -1
  s_mov_b64 s[84:85], -1
  s_mov_b64 s[86:87], -1
  s_mov_b32 s70, 131072
L_ap_poll:
  s_mov_b64 exec, s[72:73]
  s_cbranch_execz L_ap_skip_22
  global_load_dwordx4 v[16:19], v11, s[42:43] offset:-4096 sc1
L_ap_skip_22:
  s_mov_b64 exec, s[74:75]
  s_cbranch_execz L_ap_skip_23
  global_load_dwordx4 v[20:23], v11, s[42:43] offset:-2048 sc1
L_ap_skip_23:
  s_mov_b64 exec, s[76:77]
  s_cbranch_execz L_ap_skip_24
  global_load_dwordx4 v[24:27], v11, s[42:43] offset:0 sc1
L_ap_skip_24:
  s_mov_b64 exec, s[78:79]
  s_cbranch_execz L_ap_skip_25
  global_load_dwordx4 v[28:31], v11, s[42:43] offset:2048 sc1
L_ap_skip_25:
  s_mov_b64 exec, s[80:81]
  s_cbranch_execz L_ap_skip_26
  global_load_dwordx4 v[32:35], v12, s[42:43] offset:-4096 sc1
L_ap_skip_26:
  s_mov_b64 exec, s[82:83]
  s_cbranch_execz L_ap_skip_27
  global_load_dwordx4 v[36:39], v12, s[42:43] offset:-2048 sc1
L_ap_skip_27:
  s_mov_b64 exec, s[84:85]
  s_cbranch_execz L_ap_skip_28
  global_load_dwordx4 v[40:43], v12, s[42:43] offset:0 sc1
L_ap_skip_28:
  s_mov_b64 exec, s[86:87]
  s_cbranch_execz L_ap_skip_29
  global_load_dwordx4 v[44:47], v12, s[42:43] offset:2048 sc1
L_ap_skip_29:
  s_mov_b32 s71, 0
  s_waitcnt vmcnt(0)
  s_mov_b64 exec, s[72:73]
  s_cbranch_execz L_ap_skip_30
  v_max3_u32 v14, v16, v17, v18
  v_max_u32 v14, v14, v19
  v_cmp_eq_u32 vcc, -1, v14
  s_mov_b64 s[72:73], vcc
  s_bcnt1_i32_b64 s50, vcc
  s_add_u32 s71, s71, s50
L_ap_skip_30:
  s_mov_b64 exec, s[74:75]
  s_cbranch_execz L_ap_skip_31
  v_max3_u32 v14, v20, v21, v22
  v_max_u32 v14, v14, v23
  v_cmp_eq_u32 vcc, -1, v14
  s_mov_b64 s[74:75], vcc
  s_bcnt1_i32_b64 s50, vcc
  s_add_u32 s71, s71, s50
L_ap_skip_31:
  s_mov_b64 exec, s[76:77]
  s_cbranch_execz L_ap_skip_32
  v_max3_u32 v14, v24, v25, v26
  v_max_u32 v14, v14, v27
  v_cmp_eq_u32 vcc, -1, v14
  s_mov_b64 s[76:77], vcc
  s_bcnt1_i32_b64 s50, vcc
  s_add_u32 s71, s71, s50
L_ap_skip_32:
  s_mov_b64 exec, s[78:79]
  s_cbranch_execz L_ap_skip_33
  v_max3_u32 v14, v28, v29, v30
  v_max_u32 v14, v14, v31
  v_cmp_eq_u32 vcc, -1, v14
  s_mov_b64 s[78:79], vcc
  s_bcnt1_i32_b64 s50, vcc
  s_add_u32 s71, s71, s50
L_ap_skip_33:
  s_mov_b64 exec, s[80:81]
  s_cbranch_execz L_ap_skip_34
  v_max3_u32 v14, v32, v33, v34
  v_max_u32 v14, v14, v35
  v_cmp_eq_u32 vcc, -1, v14
  s_mov_b64 s[80:81], vcc
  s_bcnt1_i32_b64 s50, vcc
  s_add_u32 s71, s71, s50
L_ap_skip_34:
  s_mov_b64 exec, s[82:83]
  s_cbranch_execz L_ap_skip_35
  v_max3_u32 v14, v36, v37, v38
  v_max_u32 v14, v14, v39
  v_cmp_eq_u32 vcc, -1, v14
  s_mov_b64 s[82:83], vcc
  s_bcnt1_i32_b64 s50, vcc
  s_add_u32 s71, s71, s50
L_ap_skip_35:
  s_mov_b64 exec, s[84:85]
  s_cbranch_execz L_ap_skip_36
  v_max3_u32 v14, v40, v41, v42
  v_max_u32 v14, v14, v43
  v_cmp_eq_u32 vcc, -1, v14
  s_mov_b64 s[84:85], vcc
  s_bcnt1_i32_b64 s50, vcc
  s_add_u32 s71, s71, s50
L_ap_skip_36:
  s_mov_b64 exec, s[86:87]
  s_cbranch_execz L_ap_skip_37
  v_max3_u32 v14, v44, v45, v46
  v_max_u32 v14, v14, v47
  v_cmp_eq_u32 vcc, -1, v14
  s_mov_b64 s[86:87], vcc
  s_bcnt1_i32_b64 s50, vcc
  s_add_u32 s71, s71, s50
L_ap_skip_37:
  s_cmp_eq_u32 s71, 0
  s_cbranch_scc1 L_ap_done
  s_sub_u32 s70, s70, 1
  s_cmp_eq_u32 s70, 0
  s_cbranch_scc1 L_ap_done
  s_cmp_le_u32 s71, 64
  s_cbranch_scc1 L_ap_poll
  s_sleep 1
  s_cmp_le_u32 s71, 128
  s_cbranch_scc1 L_ap_poll
  s_sleep 2
  s_cmp_le_u32 s71, 256
  s_cbranch_scc1 L_ap_poll
  s_sleep 8
  s_branch L_ap_poll
L_ap_done:
  s_mov_b64 exec, -1
  v_pk_add_f32 v[16:17], v[16:17], v[32:33]
  v_pk_add_f32 v[18:19], v[18:19], v[34:35]
  v_pk_add_f32 v[20:21], v[20:21], v[36:37]
  v_pk_add_f32 v[22:23], v[22:23], v[38:39]
  v_pk_add_f32 v[24:25], v[24:25], v[40:41]
  v_pk_add_f32 v[26:27], v[26:27], v[42:43]
  v_pk_add_f32 v[28:29], v[28:29], v[44:45]
  v_pk_add_f32 v[30:31], v[30:31], v[46:47]
  v_pk_add_f32 v[16:17], v[16:17], v[24:25]
  v_pk_add_f32 v[18:19], v[18:19], v[26:27]
  v_pk_add_f32 v[20:21], v[20:21], v[28:29]
  v_pk_add_f32 v[22:23], v[22:23], v[30:31]
  v_pk_add_f32 v[16:17], v[16:17], v[20:21]
  v_pk_add_f32 v[18:19], v[18:19], v[22:23]
  ds_write_b128 v13, v[16:19] offset:13312
  v_lshlrev_b32 v10, 5, v0
  s_waitcnt lgkmcnt(0)
  s_barrier
  s_cmp_lt_u32 s3, 4
  s_cbranch_scc1 L_end
  ds_read_b128 v[16:19], v10 offset:13312
  ds_read_b128 v[20:23], v10 offset:13328
  ds_read_b128 v[24:27], v10 offset:15360
  ds_read_b128 v[28:31], v10 offset:15376
  ds_read_b128 v[32:35], v10 offset:17408
  ds_read_b128 v[36:39], v10 offset:17424
  ds_read_b128 v[40:43], v10 offset:19456
  ds_read_b128 v[44:47], v10 offset:19472
  v_mov_b32 v232, 0
  v_mov_b32 v240, 0
  v_mov_b32 v233, 0
  v_mov_b32 v241, 0
  v_mov_b32 v234, 0
  v_mov_b32 v242, 0
  v_mov_b32 v235, 0
  v_mov_b32 v243, 0
  v_mov_b32 v236, 0
  v_mov_b32 v244, 0
  v_mov_b32 v237, 0
  v_mov_b32 v245, 0
  v_mov_b32 v238, 0
  v_mov_b32 v246, 0
  v_mov_b32 v239, 0
  v_mov_b32 v247, 0
  s_waitcnt lgkmcnt(4)
  v_pk_add_f32 v[16:17], v[16:17], v[24:25]
  v_pk_add_f32 v[18:19], v[18:19], v[26:27]
  v_pk_add_f32 v[20:21], v[20:21], v[28:29]
  v_pk_add_f32 v[22:23], v[22:23], v[30:31]
  s_waitcnt lgkmcnt(0)
  v_pk_add_f32 v[32:33], v[32:33], v[40:41]
  v_pk_add_f32 v[34:35], v[34:35], v[42:43]
  v_pk_add_f32 v[36:37], v[36:37], v[44:45]
  v_pk_add_f32 v[38:39], v[38:39], v[46:47]
  v_pk_add_f32 v[16:17], v[16:17], v[32:33]
  v_pk_add_f32 v[18:19], v[18:19], v[34:35]
  v_pk_add_f32 v[20:21], v[20:21], v[36:37]
  v_pk_add_f32 v[22:23], v[22:23], v[38:39]
  v_cvt_pk_bf16_f32 v16, 0, v16
  v_cvt_pk_bf16_f32 v17, 0, v17
  v_cvt_pk_bf16_f32 v18, 0, v18
  v_cvt_pk_bf16_f32 v19, 0, v19
  v_cvt_pk_bf16_f32 v20, 0, v20
  v_cvt_pk_bf16_f32 v21, 0, v21
  v_cvt_pk_bf16_f32 v22, 0, v22
  v_cvt_pk_bf16_f32 v23, 0, v23
  v_pk_mul_f32 v[16:17], v[16:17], v[192:193]
  v_pk_mul_f32 v[18:19], v[18:19], v[194:195]
  v_pk_mul_f32 v[20:21], v[20:21], v[196:197]
  v_pk_mul_f32 v[22:23], v[22:23], v[198:199]
  v_cvt_pk_bf16_f32 v16, 0, v16
  v_cvt_pk_bf16_f32 v17, 0, v17
  v_cvt_pk_bf16_f32 v18, 0, v18
  v_cvt_pk_bf16_f32 v19, 0, v19
  v_cvt_pk_bf16_f32 v20, 0, v20
  v_cvt_pk_bf16_f32 v21, 0, v21
  v_cvt_pk_bf16_f32 v22, 0, v22
  v_cvt_pk_bf16_f32 v23, 0, v23
  v_pk_add_f32 v[16:17], v[16:17], v[216:217]
  v_pk_add_f32 v[18:19], v[18:19], v[218:219]
  v_pk_add_f32 v[20:21], v[20:21], v[220:221]
  v_pk_add_f32 v[22:23], v[22:23], v[222:223]
  v_cvt_pk_bf16_f32 v16, 0, v16
  v_cvt_pk_bf16_f32 v17, 0, v17
  v_cvt_pk_bf16_f32 v18, 0, v18
  v_cvt_pk_bf16_f32 v19, 0, v19
  v_cvt_pk_bf16_f32 v20, 0, v20
  v_cvt_pk_bf16_f32 v21, 0, v21
  v_cvt_pk_bf16_f32 v22, 0, v22
  v_cvt_pk_bf16_f32 v23, 0, v23
  ds_write_b128 v10, v[16:19] offset:29696
  ds_write_b128 v10, v[20:23] offset:29712
  v_pk_add_f32 v[32:33], v[16:17], v[18:19]
  v_pk_add_f32 v[34:35], v[20:21], v[22:23]
  v_pk_add_f32 v[32:33], v[32:33], v[34:35]
  v_add_f32 v32, v32, v33
  s_nop 1
  v_add_f32_dpp v32, v32, v32 row_ror:8 row_mask:0xf bank_mask:0xf
  s_nop 1
  v_add_f32_dpp v32, v32, v32 row_ror:4 row_mask:0xf bank_mask:0xf
  s_nop 1
  v_add_f32_dpp v32, v32, v32 row_ror:2 row_mask:0xf bank_mask:0xf
  s_nop 1
  v_add_f32_dpp v32, v32, v32 row_ror:1 row_mask:0xf bank_mask:0xf
  v_mov_b32 v33, v32
  s_nop 1
  v_permlane16_swap_b32 v32, v33
  v_add_f32 v32, v32, v33
  v_mov_b32 v33, v32
  s_nop 1
  v_permlane32_swap_b32 v32, v33
  v_add_f32 v32, v32, v33
  v_mul_f32 v32, 0x3b000000, v32
  v_cvt_pk_bf16_f32 v40, 0, v32
  v_sub_f32 v34, v16, v32
  v_sub_f32 v35, v17, v32
  v_sub_f32 v36, v18, v32
  v_sub_f32 v37, v19, v32
  v_mul_f32 v38, v34, v34
  v_mul_f32 v39, v35, v35
  v_fmac_f32 v38, v36, v36
  v_fmac_f32 v39, v37, v37
  v_sub_f32 v34, v20, v32
  v_sub_f32 v35, v21, v32
  v_sub_f32 v36, v22, v32
  v_sub_f32 v37, v23, v32
  v_fmac_f32 v38, v34, v34
  v_fmac_f32 v39, v35, v35
  v_fmac_f32 v38, v36, v36
  v_fmac_f32 v39, v37, v37
  v_add_f32 v34, v38, v39
  s_nop 1
  v_add_f32_dpp v34, v34, v34 row_ror:8 row_mask:0xf bank_mask:0xf
  s_nop 1
  v_add_f32_dpp v34, v34, v34 row_ror:4 row_mask:0xf bank_mask:0xf
  s_nop 1
  v_add_f32_dpp v34, v34, v34 row_ror:2 row_mask:0xf bank_mask:0xf
  s_nop 1
  v_add_f32_dpp v34, v34, v34 row_ror:1 row_mask:0xf bank_mask:0xf
  v_mov_b32 v33, v34
  s_nop 1
  v_permlane16_swap_b32 v34, v33
  v_add_f32 v34, v34, v33
  v_mov_b32 v33, v34
  s_nop 1
  v_permlane32_swap_b32 v34, v33
  v_add_f32 v34, v34, v33
  v_mul_f32 v34, 0x3b000000, v34
  v_cvt_pk_bf16_f32 v34, 0, v34
  v_add_f32 v34, 0x3727c5ac, v34
  v_cvt_pk_bf16_f32 v34, 0, v34
  v_sqrt_f32 v32, v34
  s_nop 0
  v_rcp_f32 v33, v32
  v_fma_f32 v35, -v32, v32, v34
  v_mul_f32 v33, 0.5, v33
  v_fma_f32 v32, v35, v33, v32
  v_cvt_pk_bf16_f32 v41, 0, v32
  v_rcp_f32 v42, v41
  s_nop 0
  v_sub_f32 v32, v16, v40
  v_sub_f32 v33, v17, v40
  v_sub_f32 v34, v18, v40
  v_sub_f32 v35, v19, v40
  v_sub_f32 v36, v20, v40
  v_sub_f32 v37, v21, v40
  v_sub_f32 v38, v22, v40
  v_sub_f32 v39, v23, v40
  v_cvt_pk_bf16_f32 v32, 0, v32
  v_cvt_pk_bf16_f32 v33, 0, v33
  v_cvt_pk_bf16_f32 v34, 0, v34
  v_cvt_pk_bf16_f32 v35, 0, v35
  v_cvt_pk_bf16_f32 v36, 0, v36
  v_cvt_pk_bf16_f32 v37, 0, v37
  v_cvt_pk_bf16_f32 v38, 0, v38
  v_cvt_pk_bf16_f32 v39, 0, v39
  v_mul_f32 v24, v32, v42
  v_mul_f32 v25, v33, v42
  v_mul_f32 v26, v34, v42
  v_mul_f32 v27, v35, v42
  v_mul_f32 v28, v36, v42
  v_mul_f32 v29, v37, v42
  v_mul_f32 v30, v38, v42
  v_mul_f32 v31, v39, v42
  v_fma_f32 v248, -v24, v41, v32
  v_fma_f32 v249, -v25, v41, v33
  v_fma_f32 v250, -v26, v41, v34
  v_fma_f32 v251, -v27, v41, v35
  v_fma_f32 v252, -v28, v41, v36
  v_fma_f32 v253, -v29, v41, v37
  v_fma_f32 v254, -v30, v41, v38
  v_fma_f32 v255, -v31, v41, v39
  v_fma_f32 v24, v248, v42, v24
  v_fma_f32 v25, v249, v42, v25
  v_fma_f32 v26, v250, v42, v26
  v_fma_f32 v27, v251, v42, v27
  v_fma_f32 v28, v252, v42, v28
  v_fma_f32 v29, v253, v42, v29
  v_fma_f32 v30, v254, v42, v30
  v_fma_f32 v31, v255, v42, v31
  v_cvt_pk_bf16_f32 v24, 0, v24
  v_cvt_pk_bf16_f32 v25, 0, v25
  v_cvt_pk_bf16_f32 v26, 0, v26
  v_cvt_pk_bf16_f32 v27, 0, v27
  v_cvt_pk_bf16_f32 v28, 0, v28
  v_cvt_pk_bf16_f32 v29, 0, v29
  v_cvt_pk_bf16_f32 v30, 0, v30
  v_cvt_pk_bf16_f32 v31, 0, v31
  v_mul_f32 v24, v24, v208
  v_mul_f32 v25, v25, v209
  v_mul_f32 v26, v26, v210
  v_mul_f32 v27, v27, v211
  v_mul_f32 v28, v28, v212
  v_mul_f32 v29, v29, v213
  v_mul_f32 v30, v30, v214
  v_mul_f32 v31, v31, v215
  v_cvt_pk_bf16_f32 v24, 0, v24
  v_cvt_pk_bf16_f32 v25, 0, v25
  v_cvt_pk_bf16_f32 v26, 0, v26
  v_cvt_pk_bf16_f32 v27, 0, v27
  v_cvt_pk_bf16_f32 v28, 0, v28
  v_cvt_pk_bf16_f32 v29, 0, v29
  v_cvt_pk_bf16_f32 v30, 0, v30
  v_cvt_pk_bf16_f32 v31, 0, v31
  v_add_f32 v24, v24, v200
  v_add_f32 v25, v25, v201
  v_add_f32 v26, v26, v202
  v_add_f32 v27, v27, v203
  v_add_f32 v28, v28, v204
  v_add_f32 v29, v29, v205
  v_add_f32 v30, v30, v206
  v_add_f32 v31, v31, v207
  v_cvt_pk_bf16_f32 v24, 0, v24
  v_cvt_pk_bf16_f32 v25, 0, v25
  v_cvt_pk_bf16_f32 v26, 0, v26
  v_cvt_pk_bf16_f32 v27, 0, v27
  v_cvt_pk_bf16_f32 v28, 0, v28
  v_cvt_pk_bf16_f32 v29, 0, v29
  v_cvt_pk_bf16_f32 v30, 0, v30
  v_cvt_pk_bf16_f32 v31, 0, v31
  v_lshrrev_b32 v32, 16, v24
  v_lshrrev_b32 v33, 16, v25
  v_lshrrev_b32 v34, 16, v26
  v_lshrrev_b32 v35, 16, v27
  v_lshrrev_b32 v36, 16, v28
  v_lshrrev_b32 v37, 16, v29
  v_lshrrev_b32 v38, 16, v30
  v_lshrrev_b32 v39, 16, v31
  v_dot2c_f32_bf16 v232, v32, v80
  v_dot2c_f32_bf16 v233, v24, v80
  v_dot2c_f32_bf16 v234, v32, v81
  v_dot2c_f32_bf16 v235, v24, v81
  v_dot2c_f32_bf16 v236, v32, v82
  v_dot2c_f32_bf16 v237, v24, v82
  v_dot2c_f32_bf16 v238, v32, v83
  v_dot2c_f32_bf16 v239, v24, v83
  v_dot2c_f32_bf16 v240, v32, v112
  v_dot2c_f32_bf16 v241, v24, v112
  v_dot2c_f32_bf16 v242, v32, v113
  v_dot2c_f32_bf16 v243, v24, v113
  v_dot2c_f32_bf16 v244, v32, v114
  v_dot2c_f32_bf16 v245, v24, v114
  v_dot2c_f32_bf16 v246, v32, v115
  v_dot2c_f32_bf16 v247, v24, v115
  v_dot2c_f32_bf16 v232, v33, v84
  v_dot2c_f32_bf16 v233, v25, v84
  v_dot2c_f32_bf16 v234, v33, v85
  v_dot2c_f32_bf16 v235, v25, v85
  v_dot2c_f32_bf16 v236, v33, v86
  v_dot2c_f32_bf16 v237, v25, v86
  v_dot2c_f32_bf16 v238, v33, v87
  v_dot2c_f32_bf16 v239, v25, v87
  v_dot2c_f32_bf16 v240, v33, v116
  v_dot2c_f32_bf16 v241, v25, v116
  v_dot2c_f32_bf16 v242, v33, v117
  v_dot2c_f32_bf16 v243, v25, v117
  v_dot2c_f32_bf16 v244, v33, v118
  v_dot2c_f32_bf16 v245, v25, v118
  v_dot2c_f32_bf16 v246, v33, v119
  v_dot2c_f32_bf16 v247, v25, v119
  v_dot2c_f32_bf16 v232, v34, v88
  v_dot2c_f32_bf16 v233, v26, v88
  v_dot2c_f32_bf16 v234, v34, v89
  v_dot2c_f32_bf16 v235, v26, v89
  v_dot2c_f32_bf16 v236, v34, v90
  v_dot2c_f32_bf16 v237, v26, v90
  v_dot2c_f32_bf16 v238, v34, v91
  v_dot2c_f32_bf16 v239, v26, v91
  v_dot2c_f32_bf16 v240, v34, v120
  v_dot2c_f32_bf16 v241, v26, v120
  v_dot2c_f32_bf16 v242, v34, v121
  v_dot2c_f32_bf16 v243, v26, v121
  v_dot2c_f32_bf16 v244, v34, v122
  v_dot2c_f32_bf16 v245, v26, v122
  v_dot2c_f32_bf16 v246, v34, v123
  v_dot2c_f32_bf16 v247, v26, v123
  v_dot2c_f32_bf16 v232, v35, v92
  v_dot2c_f32_bf16 v233, v27, v92
  v_dot2c_f32_bf16 v234, v35, v93
  v_dot2c_f32_bf16 v235, v27, v93
  v_dot2c_f32_bf16 v236, v35, v94
  v_dot2c_f32_bf16 v237, v27, v94
  v_dot2c_f32_bf16 v238, v35, v95
  v_dot2c_f32_bf16 v239, v27, v95
  v_dot2c_f32_bf16 v240, v35, v124
  v_dot2c_f32_bf16 v241, v27, v124
  v_dot2c_f32_bf16 v242, v35, v125
  v_dot2c_f32_bf16 v243, v27, v125
  v_dot2c_f32_bf16 v244, v35, v126
  v_dot2c_f32_bf16 v245, v27, v126
  v_dot2c_f32_bf16 v246, v35, v127
  v_dot2c_f32_bf16 v247, v27, v127
  v_dot2c_f32_bf16 v232, v36, v96
  v_dot2c_f32_bf16 v233, v28, v96
  v_dot2c_f32_bf16 v234, v36, v97
  v_dot2c_f32_bf16 v235, v28, v97
  v_dot2c_f32_bf16 v236, v36, v98
  v_dot2c_f32_bf16 v237, v28, v98
  v_dot2c_f32_bf16 v238, v36, v99
  v_dot2c_f32_bf16 v239, v28, v99
  v_dot2c_f32_bf16 v240, v36, v128
  v_dot2c_f32_bf16 v241, v28, v128
  v_dot2c_f32_bf16 v242, v36, v129
  v_dot2c_f32_bf16 v243, v28, v129
  v_dot2c_f32_bf16 v244, v36, v130
  v_dot2c_f32_bf16 v245, v28, v130
  v_dot2c_f32_bf16 v246, v36, v131
  v_dot2c_f32_bf16 v247, v28, v131
  v_dot2c_f32_bf16 v232, v37, v100
  v_dot2c_f32_bf16 v233, v29, v100
  v_dot2c_f32_bf16 v234, v37, v101
  v_dot2c_f32_bf16 v235, v29, v101
  v_dot2c_f32_bf16 v236, v37, v102
  v_dot2c_f32_bf16 v237, v29, v102
  v_dot2c_f32_bf16 v238, v37, v103
  v_dot2c_f32_bf16 v239, v29, v103
  v_dot2c_f32_bf16 v240, v37, v132
  v_dot2c_f32_bf16 v241, v29, v132
  v_dot2c_f32_bf16 v242, v37, v133
  v_dot2c_f32_bf16 v243, v29, v133
  v_dot2c_f32_bf16 v244, v37, v134
  v_dot2c_f32_bf16 v245, v29, v134
  v_dot2c_f32_bf16 v246, v37, v135
  v_dot2c_f32_bf16 v247, v29, v135
  v_dot2c_f32_bf16 v232, v38, v104
  v_dot2c_f32_bf16 v233, v30, v104
  v_dot2c_f32_bf16 v234, v38, v105
  v_dot2c_f32_bf16 v235, v30, v105
  v_dot2c_f32_bf16 v236, v38, v106
  v_dot2c_f32_bf16 v237, v30, v106
  v_dot2c_f32_bf16 v238, v38, v107
  v_dot2c_f32_bf16 v239, v30, v107
  v_dot2c_f32_bf16 v240, v38, v136
  v_dot2c_f32_bf16 v241, v30, v136
  v_dot2c_f32_bf16 v242, v38, v137
  v_dot2c_f32_bf16 v243, v30, v137
  v_dot2c_f32_bf16 v244, v38, v138
  v_dot2c_f32_bf16 v245, v30, v138
  v_dot2c_f32_bf16 v246, v38, v139
  v_dot2c_f32_bf16 v247, v30, v139
  v_dot2c_f32_bf16 v232, v39, v108
  v_dot2c_f32_bf16 v233, v31, v108
  v_dot2c_f32_bf16 v234, v39, v109
  v_dot2c_f32_bf16 v235, v31, v109
  v_dot2c_f32_bf16 v236, v39, v110
  v_dot2c_f32_bf16 v237, v31, v110
  v_dot2c_f32_bf16 v238, v39, v111
  v_dot2c_f32_bf16 v239, v31, v111
  v_dot2c_f32_bf16 v240, v39, v140
  v_dot2c_f32_bf16 v241, v31, v140
  v_dot2c_f32_bf16 v242, v39, v141
  v_dot2c_f32_bf16 v243, v31, v141
  v_dot2c_f32_bf16 v244, v39, v142
  v_dot2c_f32_bf16 v245, v31, v142
  v_dot2c_f32_bf16 v246, v39, v143
  v_dot2c_f32_bf16 v247, v31, v143
  v_lshlrev_b32 v10, 5, v0
  s_lshl_b32 s50, s6, 11
  v_add_u32 v10, s50, v10
  s_nop 1
  v_permlane32_swap_b32 v232, v236
  v_permlane32_swap_b32 v233, v237
  v_permlane32_swap_b32 v234, v238
  v_permlane32_swap_b32 v235, v239
  v_permlane32_swap_b32 v240, v244
  v_permlane32_swap_b32 v241, v245
  v_permlane32_swap_b32 v242, v246
  v_permlane32_swap_b32 v243, v247
  v_add_f32 v232, v232, v236
  v_add_f32 v233, v233, v237
  v_add_f32 v234, v234, v238
  v_add_f32 v235, v235, v239
  v_add_f32 v240, v240, v244
  v_add_f32 v241, v241, v245
  v_add_f32 v242, v242, v246
  v_add_f32 v243, v243, v247
  v_permlane16_swap_b32 v232, v234
  v_permlane16_swap_b32 v233, v235
  v_permlane16_swap_b32 v240, v242
  v_permlane16_swap_b32 v241, v243
  v_add_f32 v232, v232, v234
  v_add_f32 v233, v233, v235
  v_add_f32 v240, v240, v242
  v_add_f32 v241, v241, v243
  v_add_f32_dpp v232, v232, v232 row_ror:8 row_mask:0xf bank_mask:0xf
  v_add_f32_dpp v233, v233, v233 row_ror:8 row_mask:0xf bank_mask:0xf
  v_add_f32_dpp v240, v240, v240 row_ror:8 row_mask:0xf bank_mask:0xf
  v_add_f32_dpp v241, v241, v241 row_ror:8 row_mask:0xf bank_mask:0xf
  v_add_f32_dpp v232, v232, v232 row_ror:4 row_mask:0xf bank_mask:0xf
  v_add_f32_dpp v233, v233, v233 row_ror:4 row_mask:0xf bank_mask:0xf
  v_add_f32_dpp v240, v240, v240 row_ror:4 row_mask:0xf bank_mask:0xf
  v_add_f32_dpp v241, v241, v241 row_ror:4 row_mask:0xf bank_mask:0xf
  v_add_f32_dpp v232, v232, v232 row_ror:2 row_mask:0xf bank_mask:0xf
  v_add_f32_dpp v233, v233, v233 row_ror:2 row_mask:0xf bank_mask:0xf
  v_add_f32_dpp v240, v240, v240 row_ror:2 row_mask:0xf bank_mask:0xf
  v_add_f32_dpp v241, v241, v241 row_ror:2 row_mask:0xf bank_mask:0xf
  v_add_f32_dpp v232, v232, v232 row_ror:1 row_mask:0xf bank_mask:0xf
  v_add_f32_dpp v233, v233, v233 row_ror:1 row_mask:0xf bank_mask:0xf
  v_add_f32_dpp v240, v240, v240 row_ror:1 row_mask:0xf bank_mask:0xf
  v_add_f32_dpp v241, v241, v241 row_ror:1 row_mask:0xf bank_mask:0xf
  v_cvt_pk_bf16_f32 v232, 0, v232
  v_cvt_pk_bf16_f32 v233, 0, v233
  v_cvt_pk_bf16_f32 v240, 0, v240
  v_cvt_pk_bf16_f32 v241, 0, v241
  v_mov_b32 v16, 0x3d372713
  v_mul_f32 v18, v232, v232
  v_mul_f32 v19, v233, v233
  v_mul_f32 v18, v18, v232
  v_mul_f32 v19, v19, v233
  v_fma_f32 v18, v18, v16, v232
  v_fma_f32 v19, v19, v16, v233
  v_mul_f32 v18, 0xc0135761, v18
  v_mul_f32 v19, 0xc0135761, v19
  v_min_f32 v36, 0x42fc0000, v18
  v_min_f32 v37, 0x42fc0000, v19
  v_exp_f32 v36, v36
  v_exp_f32 v37, v37
  v_add_f32 v36, 1.0, v36
  v_add_f32 v37, 1.0, v37
  v_rcp_f32 v32, v36
  v_rcp_f32 v33, v37
  v_mul_f32 v20, v232, v32
  v_mul_f32 v21, v233, v33
  v_fma_f32 v34, -v20, v36, v232
  v_fma_f32 v35, -v21, v37, v233
  v_fma_f32 v20, v34, v32, v20
  v_fma_f32 v21, v35, v33, v21
  v_cvt_pk_bf16_f32 v20, 0, v20
  v_cvt_pk_bf16_f32 v21, 0, v21
  v_mul_f32 v20, v20, v240
  v_mul_f32 v21, v21, v241
  v_cvt_pk_bf16_f32 v20, 0, v20
  v_cvt_pk_bf16_f32 v21, 0, v21
  v_mov_b32 v24, 0
  v_mov_b32 v25, 0
  v_mov_b32 v26, 0
  v_mov_b32 v27, 0
  v_mov_b32 v28, 0
  v_mov_b32 v29, 0
  v_mov_b32 v30, 0
  v_mov_b32 v31, 0
  v_readlane_b32 s72, v20, 0
  v_readlane_b32 s73, v21, 0
  v_readlane_b32 s74, v20, 16
  v_readlane_b32 s75, v21, 16
  v_readlane_b32 s76, v20, 32
  v_readlane_b32 s77, v21, 32
  v_readlane_b32 s78, v20, 48
  v_readlane_b32 s79, v21, 48
  s_lshl_b32 s50, s6, 9
  v_add_u32 v11, s50, v6
  s_lshr_b32 s80, s72, 16
  s_lshr_b32 s81, s73, 16
  s_lshr_b32 s82, s74, 16
  s_lshr_b32 s83, s75, 16
  s_lshr_b32 s84, s76, 16
  s_lshr_b32 s85, s77, 16
  s_lshr_b32 s86, s78, 16
  s_lshr_b32 s87, s79, 16
  v_dot2c_f32_bf16 v24, s80, v144
  v_dot2c_f32_bf16 v25, s72, v144
  v_dot2c_f32_bf16 v26, s80, v145
  v_dot2c_f32_bf16 v27, s72, v145
  v_dot2c_f32_bf16 v28, s80, v146
  v_dot2c_f32_bf16 v29, s72, v146
  v_dot2c_f32_bf16 v30, s80, v147
  v_dot2c_f32_bf16 v31, s72, v147
  v_dot2c_f32_bf16 v24, s81, v148
  v_dot2c_f32_bf16 v25, s73, v148
  v_dot2c_f32_bf16 v26, s81, v149
  v_dot2c_f32_bf16 v27, s73, v149
  v_dot2c_f32_bf16 v28, s81, v150
  v_dot2c_f32_bf16 v29, s73, v150
  v_dot2c_f32_bf16 v30, s81, v151
  v_dot2c_f32_bf16 v31, s73, v151
  v_dot2c_f32_bf16 v24, s82, v152
  v_dot2c_f32_bf16 v25, s74, v152
  v_dot2c_f32_bf16 v26, s82, v153
  v_dot2c_f32_bf16 v27, s74, v153
  v_dot2c_f32_bf16 v28, s82, v154
  v_dot2c_f32_bf16 v29, s74, v154
  v_dot2c_f32_bf16 v30, s82, v155
  v_dot2c_f32_bf16 v31, s74, v155
  v_dot2c_f32_bf16 v24, s83, v156
  v_dot2c_f32_bf16 v25, s75, v156
  v_dot2c_f32_bf16 v26, s83, v157
  v_dot2c_f32_bf16 v27, s75, v157
  v_dot2c_f32_bf16 v28, s83, v158
  v_dot2c_f32_bf16 v29, s75, v158
  v_dot2c_f32_bf16 v30, s83, v159
  v_dot2c_f32_bf16 v31, s75, v159
  v_dot2c_f32_bf16 v24, s84, v160
  v_dot2c_f32_bf16 v25, s76, v160
  v_dot2c_f32_bf16 v26, s84, v161
  v_dot2c_f32_bf16 v27, s76, v161
  v_dot2c_f32_bf16 v28, s84, v162
  v_dot2c_f32_bf16 v29, s76, v162
  v_dot2c_f32_bf16 v30, s84, v163
  v_dot2c_f32_bf16 v31, s76, v163
  v_dot2c_f32_bf16 v24, s85, v164
  v_dot2c_f32_bf16 v25, s77, v164
  v_dot2c_f32_bf16 v26, s85, v165
  v_dot2c_f32_bf16 v27, s77, v165
  v_dot2c_f32_bf16 v28, s85, v166
  v_dot2c_f32_bf16 v29, s77, v166
  v_dot2c_f32_bf16 v30, s85, v167
  v_dot2c_f32_bf16 v31, s77, v167
  v_dot2c_f32_bf16 v24, s86, v168
  v_dot2c_f32_bf16 v25, s78, v168
  v_dot2c_f32_bf16 v26, s86, v169
  v_dot2c_f32_bf16 v27, s78, v169
  v_dot2c_f32_bf16 v28, s86, v170
  v_dot2c_f32_bf16 v29, s78, v170
  v_dot2c_f32_bf16 v30, s86, v171
  v_dot2c_f32_bf16 v31, s78, v171
  v_dot2c_f32_bf16 v24, s87, v172
  v_dot2c_f32_bf16 v25, s79, v172
  v_dot2c_f32_bf16 v26, s87, v173
  v_dot2c_f32_bf16 v27, s79, v173
  v_dot2c_f32_bf16 v28, s87, v174
  v_dot2c_f32_bf16 v29, s79, v174
  v_dot2c_f32_bf16 v30, s87, v175
  v_dot2c_f32_bf16 v31, s79, v175
  s_lshl_b32 s51, s57, 11
  s_add_u32 s51, s51, 262144
  v_add_u32 v12, s51, v11
  s_nop 0
  ds_write_b128 v10, v[24:27] offset:21504
  ds_write_b128 v10, v[28:31] offset:21520
  s_waitcnt lgkmcnt(0)
  s_barrier
  s_mov_b64 exec, 0xffffffff
  ds_read_b128 v[16:19], v11 offset:21504
  ds_read_b128 v[20:23], v11 offset:23552
  ds_read_b128 v[24:27], v11 offset:25600
  ds_read_b128 v[28:31], v11 offset:27648
  s_waitcnt lgkmcnt(0)
  v_pk_add_f32 v[16:17], v[16:17], v[20:21]
  v_pk_add_f32 v[24:25], v[24:25], v[28:29]
  v_pk_add_f32 v[18:19], v[18:19], v[22:23]
  v_pk_add_f32 v[26:27], v[26:27], v[30:31]
  v_pk_add_f32 v[16:17], v[16:17], v[24:25]
  v_pk_add_f32 v[18:19], v[18:19], v[26:27]
  v_min_u32 v16, -2, v16
  v_min_u32 v17, -2, v17
  v_min_u32 v18, -2, v18
  v_min_u32 v19, -2, v19
  global_store_dwordx4 v12, v[16:19], s[42:43] sc1
  s_nop 1
  s_mov_b64 exec, -1
  s_cmp_ge_u32 s57, 16
  s_cbranch_scc1 L_end
  s_cmp_lg_u32 s3, 4
  s_cbranch_scc1 L_end
  v_lshrrev_b32 v10, 3, v0
  v_lshlrev_b32 v10, 11, v10
  v_and_b32 v11, 7, v0
  v_lshl_add_u32 v10, v11, 4, v10
  s_lshl_b32 s50, s57, 7
  s_add_u32 s51, s50, 262144
  v_add_u32 v52, s51, v10
  v_add_u32 v53, 16384, v52
  v_add_u32 v54, 32768, v52
  v_add_u32 v55, 49152, v52
  v_add_u32 v56, 65536, v52
  v_add_u32 v57, 81920, v52
  v_add_u32 v58, 98304, v52
  v_add_u32 v13, s50, v48
  ds_read_b32 v15, v13 offset:29696
  v_lshrrev_b32 v12, 1, v13
  s_mov_b64 s[72:73], -1
  s_mov_b64 s[74:75], -1
  s_mov_b64 s[76:77], -1
  s_mov_b64 s[78:79], -1
  s_mov_b64 s[80:81], -1
  s_mov_b64 s[82:83], -1
  s_mov_b64 s[84:85], -1
  s_mov_b32 s70, 131072
L_dp_poll:
  s_mov_b64 exec, s[72:73]
  s_cbranch_execz L_dp_skip_38
  global_load_dwordx4 v[16:19], v52, s[42:43] sc1
L_dp_skip_38:
  s_mov_b64 exec, s[74:75]
  s_cbranch_execz L_dp_skip_39
  global_load_dwordx4 v[20:23], v53, s[42:43] sc1
L_dp_skip_39:
  s_mov_b64 exec, s[76:77]
  s_cbranch_execz L_dp_skip_40
  global_load_dwordx4 v[24:27], v54, s[42:43] sc1
L_dp_skip_40:
  s_mov_b64 exec, s[78:79]
  s_cbranch_execz L_dp_skip_41
  global_load_dwordx4 v[28:31], v55, s[42:43] sc1
L_dp_skip_41:
  s_mov_b64 exec, s[80:81]
  s_cbranch_execz L_dp_skip_42
  global_load_dwordx4 v[32:35], v56, s[42:43] sc1
L_dp_skip_42:
  s_mov_b64 exec, s[82:83]
  s_cbranch_execz L_dp_skip_43
  global_load_dwordx4 v[36:39], v57, s[42:43] sc1
L_dp_skip_43:
  s_mov_b64 exec, s[84:85]
  s_cbranch_execz L_dp_skip_44
  global_load_dwordx4 v[40:43], v58, s[42:43] sc1
L_dp_skip_44:
  s_mov_b32 s71, 0
  s_waitcnt vmcnt(0)
  s_mov_b64 exec, s[72:73]
  s_cbranch_execz L_dp_skip_45
  v_max3_u32 v51, v16, v17, v18
  v_max_u32 v51, v51, v19
  v_cmp_eq_u32 vcc, -1, v51
  s_mov_b64 s[72:73], vcc
  s_bcnt1_i32_b64 s50, vcc
  s_add_u32 s71, s71, s50
L_dp_skip_45:
  s_mov_b64 exec, s[74:75]
  s_cbranch_execz L_dp_skip_46
  v_max3_u32 v51, v20, v21, v22
  v_max_u32 v51, v51, v23
  v_cmp_eq_u32 vcc, -1, v51
  s_mov_b64 s[74:75], vcc
  s_bcnt1_i32_b64 s50, vcc
  s_add_u32 s71, s71, s50
L_dp_skip_46:
  s_mov_b64 exec, s[76:77]
  s_cbranch_execz L_dp_skip_47
  v_max3_u32 v51, v24, v25, v26
  v_max_u32 v51, v51, v27
  v_cmp_eq_u32 vcc, -1, v51
  s_mov_b64 s[76:77], vcc
  s_bcnt1_i32_b64 s50, vcc
  s_add_u32 s71, s71, s50
L_dp_skip_47:
  s_mov_b64 exec, s[78:79]
  s_cbranch_execz L_dp_skip_48
  v_max3_u32 v51, v28, v29, v30
  v_max_u32 v51, v51, v31
  v_cmp_eq_u32 vcc, -1, v51
  s_mov_b64 s[78:79], vcc
  s_bcnt1_i32_b64 s50, vcc
  s_add_u32 s71, s71, s50
L_dp_skip_48:
  s_mov_b64 exec, s[80:81]
  s_cbranch_execz L_dp_skip_49
  v_max3_u32 v51, v32, v33, v34
  v_max_u32 v51, v51, v35
  v_cmp_eq_u32 vcc, -1, v51
  s_mov_b64 s[80:81], vcc
  s_bcnt1_i32_b64 s50, vcc
  s_add_u32 s71, s71, s50
L_dp_skip_49:
  s_mov_b64 exec, s[82:83]
  s_cbranch_execz L_dp_skip_50
  v_max3_u32 v51, v36, v37, v38
  v_max_u32 v51, v51, v39
  v_cmp_eq_u32 vcc, -1, v51
  s_mov_b64 s[82:83], vcc
  s_bcnt1_i32_b64 s50, vcc
  s_add_u32 s71, s71, s50
L_dp_skip_50:
  s_mov_b64 exec, s[84:85]
  s_cbranch_execz L_dp_skip_51
  v_max3_u32 v51, v40, v41, v42
  v_max_u32 v51, v51, v43
  v_cmp_eq_u32 vcc, -1, v51
  s_mov_b64 s[84:85], vcc
  s_bcnt1_i32_b64 s50, vcc
  s_add_u32 s71, s71, s50
L_dp_skip_51:
  s_cmp_eq_u32 s71, 0
  s_cbranch_scc1 L_dp_done
  s_sub_u32 s70, s70, 1
  s_cmp_eq_u32 s70, 0
  s_cbranch_scc1 L_dp_done
  s_branch L_dp_poll
L_dp_done:
  s_mov_b64 exec, -1
  v_pk_add_f32 v[16:17], v[16:17], v[20:21]
  v_pk_add_f32 v[24:25], v[24:25], v[28:29]
  v_pk_add_f32 v[32:33], v[32:33], v[36:37]
  v_pk_add_f32 v[18:19], v[18:19], v[22:23]
  v_pk_add_f32 v[26:27], v[26:27], v[30:31]
  v_pk_add_f32 v[34:35], v[34:35], v[38:39]
  v_pk_add_f32 v[16:17], v[16:17], v[24:25]
  v_pk_add_f32 v[32:33], v[32:33], v[40:41]
  v_pk_add_f32 v[18:19], v[18:19], v[26:27]
  v_pk_add_f32 v[34:35], v[34:35], v[42:43]
  v_pk_add_f32 v[16:17], v[16:17], v[32:33]
  v_pk_add_f32 v[18:19], v[18:19], v[34:35]
  s_nop 1
  v_permlane32_swap_b32 v16, v18
  v_permlane32_swap_b32 v17, v19
  v_add_f32 v16, v16, v18
  v_add_f32 v17, v17, v19
  s_nop 1
  v_permlane16_swap_b32 v16, v17
  v_add_f32 v16, v16, v17
  s_nop 1
  v_add_f32_dpp v16, v16, v16 row_ror:8 row_mask:0xf bank_mask:0xf
  s_waitcnt lgkmcnt(0)
  v_cvt_pk_bf16_f32 v16, 0, v16
  v_mul_f32 v16, v224, v16
  v_cvt_pk_bf16_f32 v16, 0, v16
  v_add_f32 v16, v15, v16
  v_cvt_pk_bf16_f32 v16, v16, v16
  s_mov_b32 exec_lo, 0x00ff00ff
  s_mov_b32 exec_hi, 0x00ff00ff
  global_store_short v12, v16, s[38:39]
  s_cmp_lg_u32 s57, 0
  s_cbranch_scc1 L_fin_noepoch
  s_mov_b64 exec, 1
  v_mov_b32 v13, 0
  global_store_dword v13, v49, s[42:43] sc1
L_fin_noepoch:
  s_mov_b64 exec, -1
L_end:
  s_endpgm
.section .rodata,"a"
.p2align 6
.amdhsa_kernel adaLN_cond__mha_block_cached__glu_gated_geglu__decode_kernel
  .amdhsa_next_free_vgpr 256
  .amdhsa_next_free_sgpr 102
  .amdhsa_accum_offset 256
  .amdhsa_group_segment_fixed_size 0
  .amdhsa_kernarg_size 112
  .amdhsa_user_sgpr_count 2
  .amdhsa_user_sgpr_kernarg_segment_ptr 1
  .amdhsa_system_sgpr_workgroup_id_x 1
.end_amdhsa_kernel
```
